```python
import torch

def _softmax(x, axis=-1):
    return torch.softmax(x, dim=axis)
def _gelu(x):
    return torch.nn.functional.gelu(x, approximate="tanh")
def _silu(x):
    return torch.nn.functional.silu(x)
def _sigmoid(x):
    return torch.sigmoid(x)
def _layernorm(x, axis=-1, eps=1e-5):
    m = x.mean(dim=axis, keepdim=True)
    v = x.var(dim=axis, keepdim=True, unbiased=False)
    return (x - m) / torch.sqrt(v + eps)
def _scatter_add(tgt, idx, src, axis=0):
    return tgt.clone().index_add_(axis, idx, src)
def _segment_sum(src, seg, n):
    out = torch.zeros((n,) + src.shape[1:], dtype=src.dtype)
    return out.index_add_(0, seg, src)
def _pad(x, pw):
    flat = tuple(v for pair in reversed(pw) for v in pair)
    return torch.nn.functional.pad(x, flat)

kernel_name = 'sequential_preLN__ssm_conv_s4__dense_activation_silu__prompt'

def setup_inputs():

    _w = (lambda a: (lambda t: t.to(torch.bfloat16) if t.is_floating_point() else t)(torch.as_tensor(a)))
    def _A_setup():
        B, L, D, N = 1, 2048, 512, 128
        A_re = -(lambda _x: torch.exp(torch.as_tensor(_x)))((lambda *s: torch.randn(*s, dtype=torch.bfloat16) * 6.4)(D, N))
        A_im = torch.pi * (lambda *s: torch.randn(*s, dtype=torch.bfloat16) * 0.05)(D, N)
        B_re = (lambda *s: torch.randn(*s, dtype=torch.bfloat16) * 0.1)(D, N)
        B_im = (lambda *s: torch.randn(*s, dtype=torch.bfloat16) * 0.1)(D, N)
        C_re = (lambda *s: torch.randn(*s, dtype=torch.bfloat16) * 0.1)(D, N)
        C_im = (lambda *s: torch.randn(*s, dtype=torch.bfloat16) * 0.1)(D, N)
        log_dt = (lambda *s: torch.randn(*s, dtype=torch.bfloat16) * 0.05)(D) * 0.5 - 4.0
        Dskip = (lambda *s: torch.randn(*s, dtype=torch.bfloat16) * 0.05)(D)
        return {
            "u": _w((lambda *s: torch.randn(*s, dtype=torch.bfloat16) * 0.05)(B, L, D)),
            "A_re": _w(A_re),
            "A_im": _w(A_im),
            "B_re": _w(B_re),
            "B_im": _w(B_im),
            "C_re": _w(C_re),
            "C_im": _w(C_im),
            "log_dt": _w(log_dt),
            "Dskip": _w(Dskip),
        }
    _A_in = _A_setup()

    def _B_setup():
        B, S, D, F = 1, 2048, 512, 1792
        return {
            "x": _w((lambda *s: torch.randn(*s, dtype=torch.bfloat16) * 0.05)(B, S, D)),
            "w1": _w((lambda *s: torch.randn(*s, dtype=torch.bfloat16) * 0.8)(D, F) * (D ** -0.5)),
            "w2": _w((lambda *s: torch.randn(*s, dtype=torch.bfloat16) * 0.2)(F, D) * (F ** -0.5)),
        }
    _B_in = _B_setup()

    return {
        "A_u": _A_in["u"],
        "A_A_re": _A_in["A_re"],
        "A_A_im": _A_in["A_im"],
        "A_B_re": _A_in["B_re"],
        "A_B_im": _A_in["B_im"],
        "A_C_re": _A_in["C_re"],
        "A_C_im": _A_in["C_im"],
        "A_log_dt": _A_in["log_dt"],
        "A_Dskip": _A_in["Dskip"],
        "B_x": _B_in["x"],
        "B_w1": _B_in["w1"],
        "B_w2": _B_in["w2"],
    }

def reference(A_u, A_A_re, A_A_im, A_B_re, A_B_im, A_C_re, A_C_im, A_log_dt, A_Dskip, B_x, B_w1, B_w2):
    def _A_ref(u, A_re, A_im, B_re, B_im, C_re, C_im, log_dt, Dskip):
        Bsz, L, D = u.shape
        dt = torch.exp(log_dt)[:, None]
        A = A_re + 1j * A_im
        Bc = B_re + 1j * B_im
        Cc = C_re + 1j * C_im
        logdA = dt * A
        dB = dt * Bc
        l = (lambda x, dt: x.to(dt))(torch.arange(L), A_re.dtype)
        P = torch.exp(logdA[:, :, None] * l[None, None, :])
        K = torch.einsum("dn,dnl,dn->dl", Cc, P, dB).real
        L2 = 2 * L
        Kp = _pad(K, ((0, 0), (0, L)))
        up = (lambda x, *d: x.permute(*d))(u, 0, 2, 1)
        up = _pad(up, ((0, 0), (0, 0), (0, L)))
        Kf = (lambda x, axes=(-2,-1): torch.fft.rfft2(x.float(), dim=axes))(Kp[:, None, :], axes=(-2, -1))
        Uf = (lambda x, axes=(-2,-1): torch.fft.rfft2(x.float(), dim=axes))(up[:, :, None, :], axes=(-2, -1))
        Yf = Uf * Kf[None, :, :, :]
        y = (lambda x, s, axes=(-2,-1): torch.fft.irfft2(x, s=s, dim=axes).to(torch.bfloat16))(Yf, (1, L2), axes=(-2, -1))[:, :, 0, :L]
        y = (lambda x, *d: x.permute(*d))(y, 0, 2, 1) + u * Dskip[None, None, :]
        return y

    def _B_ref(x, w1, w2):
        h = torch.einsum("bsd,df->bsf", x, w1)
        h = _silu(h)
        out = torch.einsum("bsf,fd->bsd", h, w2)
        return out

    x = A_u
    h = x + _A_ref(_layernorm(x, axis=-1), A_A_re, A_A_im, A_B_re, A_B_im, A_C_re, A_C_im, A_log_dt, A_Dskip)
    h2 = h + _B_ref(_layernorm(h, axis=-1), B_w1, B_w2)
    return h2
```

```asm
; @launch kernel=k1_prep_kernel grid=(688,1,1) block=(256,1,1) lds=20736
; @launch kernel=k2_conv_kernel grid=(512,1,1) block=(256,1,1) lds=71232
; @launch kernel=k3_ffn1_kernel grid=(224,1,1) block=(256,1,1) lds=163840
; @launch kernel=k4_ffn2_kernel grid=(256,1,1) block=(256,1,1) lds=98304
.amdgcn_target "amdgcn-amd-amdhsa--gfx950"
.text
.globl k1_prep_kernel
.p2align 8
.type k1_prep_kernel,@function
k1_prep_kernel:
    s_load_dwordx16 s[8:23], s[0:1], 0
    s_load_dwordx8 s[24:31], s[0:1], 64
    s_load_dwordx2 s[32:33], s[0:1], 112
    v_lshrrev_b32 v1, 6, v0
    s_nop 1
    v_readfirstlane_b32 s3, v1
    v_and_b32 v1, 63, v0
    s_waitcnt lgkmcnt(0)
    s_add_u32 s2, s2, 512
    s_cmp_lt_u32 s2, 576
    s_cbranch_scc1 K1_LN
    s_cmp_lt_u32 s2, 688
    s_cbranch_scc1 K1_TR
    s_sub_u32 s2, s2, 688
    s_mov_b32 s35, 0
    s_cmp_lt_u32 s2, 512
    s_cbranch_scc1 K1_KGEN
    s_endpgm
K1_KGEN:
    s_mov_b32 s36, s10
    s_and_b32 s37, s11, 0xffff
    s_mov_b32 s38, 131072
    s_mov_b32 s39, 0x00020000
    s_mov_b32 s40, s12
    s_and_b32 s41, s13, 0xffff
    s_mov_b32 s42, 131072
    s_mov_b32 s43, 0x00020000
    s_mov_b32 s44, s14
    s_and_b32 s45, s15, 0xffff
    s_mov_b32 s46, 131072
    s_mov_b32 s47, 0x00020000
    s_mov_b32 s48, s16
    s_and_b32 s49, s17, 0xffff
    s_mov_b32 s50, 131072
    s_mov_b32 s51, 0x00020000
    s_mov_b32 s52, s18
    s_and_b32 s53, s19, 0xffff
    s_mov_b32 s54, 131072
    s_mov_b32 s55, 0x00020000
    s_mov_b32 s56, s20
    s_and_b32 s57, s21, 0xffff
    s_mov_b32 s58, 131072
    s_mov_b32 s59, 0x00020000
    s_mov_b32 s60, s22
    s_and_b32 s61, s23, 0xffff
    s_mov_b32 s62, 1024
    s_mov_b32 s63, 0x00020000
    v_and_b32 v2, 127, v0
    v_lshlrev_b32 v3, 1, v2
    s_lshl_b32 s4, s2, 8
    v_add_u32 v3, s4, v3
    s_lshl_b32 s5, s2, 1
    v_mov_b32 v4, s5
    buffer_load_ushort v8, v3, s[36:39], 0 offen
    buffer_load_ushort v9, v3, s[40:43], 0 offen
    buffer_load_ushort v10, v3, s[44:47], 0 offen
    buffer_load_ushort v11, v3, s[48:51], 0 offen
    buffer_load_ushort v12, v3, s[52:55], 0 offen
    buffer_load_ushort v13, v3, s[56:59], 0 offen
    buffer_load_ushort v14, v4, s[60:63], 0 offen
    s_waitcnt vmcnt(0)
    v_lshlrev_b32 v8, 16, v8
    v_lshlrev_b32 v9, 16, v9
    v_lshlrev_b32 v10, 16, v10
    v_lshlrev_b32 v11, 16, v11
    v_lshlrev_b32 v12, 16, v12
    v_lshlrev_b32 v13, 16, v13
    v_lshlrev_b32 v14, 16, v14
    v_mul_f32 v14, 0x3fb8aa3b, v14
    v_exp_f32 v14, v14
    s_nop 1
    v_cvt_pk_bf16_f32 v14, v14, v14
    v_and_b32 v14, 0xffff0000, v14
    v_mul_f32 v16, v14, v8
    v_mul_f32 v17, v14, v9
    v_mul_f32 v10, v14, v10
    v_mul_f32 v11, v14, v11
    v_mul_f32 v16, 0x3fb8aa3b, v16
    v_mul_f32 v17, 0.15915494, v17
    v_mul_f32 v18, v12, v10
    v_fma_f32 v18, -v13, v11, v18
    v_mul_f32 v19, v12, v11
    v_fma_f32 v19, v13, v10, v19
    v_mov_b32 v20, v16
    v_mov_b32 v21, v17
    v_mov_b32 v22, v19
    v_mov_b32 v23, v18
    v_sub_f32 v19, 0, v19
    v_lshlrev_b32 v5, 5, v2
    ds_write_b128 v5, v[16:19]
    ds_write_b128 v5, v[20:23] offset:16
    s_waitcnt lgkmcnt(0)
    s_barrier
    v_and_b32 v2, 15, v1
    v_lshrrev_b32 v3, 4, v1
    v_lshlrev_b32 v5, 4, v3
    s_lshl_b32 s4, s3, 10
    v_add_u32 v5, s4, v5
    v_cvt_f32_u32 v7, v2
    v_lshlrev_b32 v6, 4, v2
    v_cvt_f32_u32 v6, v6
    v_add_u32 v9, 8, v2
    v_lshlrev_b32 v9, 5, v9
    v_cvt_f32_u32 v9, v9
    v_and_b32 v8, 1, v3
    v_cvt_f32_u32 v11, v8
    v_sub_f32 v10, 1.0, v11
    v_sub_f32 v11, 0, v11
    v_cvt_f32_u32 v8, v8
    v_add_f32 v8, 1.0, v8
    v_mul_f32 v8, 0x3e800000, v8
    v_mov_b32 v64, 0
    v_mov_b32 v65, 0
    v_mov_b32 v66, 0
    v_mov_b32 v67, 0
    v_mov_b32 v68, 0
    v_mov_b32 v69, 0
    v_mov_b32 v70, 0
    v_mov_b32 v71, 0
    v_mov_b32 v72, 0
    v_mov_b32 v73, 0
    v_mov_b32 v74, 0
    v_mov_b32 v75, 0
    v_mov_b32 v76, 0
    v_mov_b32 v77, 0
    v_mov_b32 v78, 0
    v_mov_b32 v79, 0
    ds_read_b128 v[32:35], v5
    s_mov_b32 s8, 8
K1_KL:
    s_waitcnt lgkmcnt(0)
    ds_read_b128 v[36:39], v5 offset:64
    v_mul_f32 v40, v32, v6
    v_mul_f32 v41, v32, v7
    v_mul_f32 v45, v32, v9
    v_fma_f32 v42, v33, v6, v8
    v_mul_f32 v43, v33, v7
    v_mul_f32 v46, v33, v9
    v_exp_f32 v40, v40
    v_exp_f32 v41, v41
    v_exp_f32 v45, v45
    v_fract_f32 v42, v42
    v_fract_f32 v43, v43
    v_fract_f32 v46, v46
    v_sin_f32 v42, v42
    v_cos_f32 v44, v43
    v_sin_f32 v43, v43
    v_cos_f32 v47, v46
    v_sin_f32 v46, v46
    v_mul_f32 v40, v40, v42
    v_mul_f32 v44, v41, v44
    v_mul_f32 v43, v41, v43
    v_mul_f32 v47, v45, v47
    v_mul_f32 v46, v45, v46

    v_mul_f32 v41, v34, v44
    v_fma_f32 v41, v35, v43, v41
    v_mul_f32 v48, v43, v43
    v_mul_f32 v49, v44, v43
    v_mfma_f32_16x16x4_f32 v[64:67], v40, v41, v[64:67]
    v_fma_f32 v44, v44, v44, -v48
    v_add_f32 v43, v49, v49
    v_mul_f32 v40, v10, v47
    v_fma_f32 v40, v11, v46, v40
    v_mul_f32 v41, v34, v44
    v_fma_f32 v41, v35, v43, v41
    v_mul_f32 v48, v43, v43
    v_mul_f32 v49, v44, v43
    v_mul_f32 v50, v46, v46
    v_mul_f32 v51, v47, v46
    v_mfma_f32_16x16x4_f32 v[68:71], v40, v41, v[68:71]
    v_fma_f32 v44, v44, v44, -v48
    v_add_f32 v43, v49, v49
    v_fma_f32 v47, v47, v47, -v50
    v_add_f32 v46, v51, v51
    v_mul_f32 v40, v10, v47
    v_fma_f32 v40, v11, v46, v40
    v_mul_f32 v41, v34, v44
    v_fma_f32 v41, v35, v43, v41
    v_mul_f32 v48, v43, v43
    v_mul_f32 v49, v44, v43
    v_mul_f32 v50, v46, v46
    v_mul_f32 v51, v47, v46
    v_mfma_f32_16x16x4_f32 v[72:75], v40, v41, v[72:75]
    v_fma_f32 v44, v44, v44, -v48
    v_add_f32 v43, v49, v49
    v_fma_f32 v47, v47, v47, -v50
    v_add_f32 v46, v51, v51
    v_mul_f32 v40, v10, v47
    v_fma_f32 v40, v11, v46, v40
    v_mul_f32 v41, v34, v44
    v_fma_f32 v41, v35, v43, v41
    s_nop 1
    v_mfma_f32_16x16x4_f32 v[76:79], v40, v41, v[76:79]
    s_waitcnt lgkmcnt(0)
    ds_read_b128 v[32:35], v5 offset:128
    v_mul_f32 v40, v36, v6
    v_mul_f32 v41, v36, v7
    v_mul_f32 v45, v36, v9
    v_fma_f32 v42, v37, v6, v8
    v_mul_f32 v43, v37, v7
    v_mul_f32 v46, v37, v9
    v_exp_f32 v40, v40
    v_exp_f32 v41, v41
    v_exp_f32 v45, v45
    v_fract_f32 v42, v42
    v_fract_f32 v43, v43
    v_fract_f32 v46, v46
    v_sin_f32 v42, v42
    v_cos_f32 v44, v43
    v_sin_f32 v43, v43
    v_cos_f32 v47, v46
    v_sin_f32 v46, v46
    v_mul_f32 v40, v40, v42
    v_mul_f32 v44, v41, v44
    v_mul_f32 v43, v41, v43
    v_mul_f32 v47, v45, v47
    v_mul_f32 v46, v45, v46

    v_mul_f32 v41, v38, v44
    v_fma_f32 v41, v39, v43, v41
    v_mul_f32 v48, v43, v43
    v_mul_f32 v49, v44, v43
    v_mfma_f32_16x16x4_f32 v[64:67], v40, v41, v[64:67]
    v_fma_f32 v44, v44, v44, -v48
    v_add_f32 v43, v49, v49
    v_mul_f32 v40, v10, v47
    v_fma_f32 v40, v11, v46, v40
    v_mul_f32 v41, v38, v44
    v_fma_f32 v41, v39, v43, v41
    v_mul_f32 v48, v43, v43
    v_mul_f32 v49, v44, v43
    v_mul_f32 v50, v46, v46
    v_mul_f32 v51, v47, v46
    v_mfma_f32_16x16x4_f32 v[68:71], v40, v41, v[68:71]
    v_fma_f32 v44, v44, v44, -v48
    v_add_f32 v43, v49, v49
    v_fma_f32 v47, v47, v47, -v50
    v_add_f32 v46, v51, v51
    v_mul_f32 v40, v10, v47
    v_fma_f32 v40, v11, v46, v40
    v_mul_f32 v41, v38, v44
    v_fma_f32 v41, v39, v43, v41
    v_mul_f32 v48, v43, v43
    v_mul_f32 v49, v44, v43
    v_mul_f32 v50, v46, v46
    v_mul_f32 v51, v47, v46
    v_mfma_f32_16x16x4_f32 v[72:75], v40, v41, v[72:75]
    v_fma_f32 v44, v44, v44, -v48
    v_add_f32 v43, v49, v49
    v_fma_f32 v47, v47, v47, -v50
    v_add_f32 v46, v51, v51
    v_mul_f32 v40, v10, v47
    v_fma_f32 v40, v11, v46, v40
    v_mul_f32 v41, v38, v44
    v_fma_f32 v41, v39, v43, v41
    s_nop 1
    v_mfma_f32_16x16x4_f32 v[76:79], v40, v41, v[76:79]
    v_add_u32 v5, 128, v5
    s_sub_u32 s8, s8, 1
    s_cmp_lg_u32 s8, 0
    s_cbranch_scc1 K1_KL
    s_waitcnt lgkmcnt(0)
    s_nop 15
    v_lshlrev_b32 v12, 4, v1
    s_lshl_b32 s4, s3, 12
    v_add_u32 v13, s4, v12
    ds_write_b128 v13, v[64:67] offset:4352
    ds_write_b128 v13, v[68:71] offset:5376
    ds_write_b128 v13, v[72:75] offset:6400
    ds_write_b128 v13, v[76:79] offset:7424
    s_waitcnt lgkmcnt(0)
    s_barrier
    s_lshl_b32 s4, s3, 10
    v_add_u32 v13, s4, v12
    ds_read_b128 v[64:67], v13 offset:4352
    ds_read_b128 v[68:71], v13 offset:8448
    ds_read_b128 v[72:75], v13 offset:12544
    ds_read_b128 v[76:79], v13 offset:16640
    s_waitcnt lgkmcnt(0)
    v_add_f32 v64, v64, v68
    v_add_f32 v72, v72, v76
    v_add_f32 v24, v64, v72
    v_add_f32 v65, v65, v69
    v_add_f32 v73, v73, v77
    v_add_f32 v25, v65, v73
    v_add_f32 v66, v66, v70
    v_add_f32 v74, v74, v78
    v_add_f32 v26, v66, v74
    v_add_f32 v67, v67, v71
    v_add_f32 v75, v75, v79
    v_add_f32 v27, v67, v75
    s_add_u32 s36, s32, 20971520
    s_addc_u32 s37, s33, 0
    s_and_b32 s37, s37, 0xffff
    s_mov_b32 s38, 8388608
    s_mov_b32 s39, 0x00020000
    s_add_u32 s4, s3, 1
    s_lshl_b32 s4, s4, 7
    s_cmp_eq_u32 s3, 0
    s_cselect_b32 s4, 0, s4
    s_cselect_b32 s5, 16, 8
    s_cmp_eq_u32 s3, 3
    s_cselect_b32 s5, 9, s5
    s_lshl_b32 s6, s2, 2
    s_add_u32 s6, s6, s35
    s_lshl_b32 s6, s6, 10
    s_add_u32 s4, s4, s6
    v_lshlrev_b32 v9, 2, v3
    v_lshlrev_b32 v10, 4, v9
    v_add_u32 v10, v10, v2
    v_add_u32 v10, s4, v10
    v_lshlrev_b32 v10, 2, v10
    v_add_u32 v11, 0, v9
    v_cmp_gt_u32 vcc, s5, v11
    s_and_saveexec_b64 s[6:7], vcc
    buffer_store_dword v24, v10, s[36:39], 0 offen offset:0
    s_mov_b64 exec, s[6:7]
    v_add_u32 v11, 1, v9
    v_cmp_gt_u32 vcc, s5, v11
    s_and_saveexec_b64 s[6:7], vcc
    buffer_store_dword v25, v10, s[36:39], 0 offen offset:64
    s_mov_b64 exec, s[6:7]
    v_add_u32 v11, 2, v9
    v_cmp_gt_u32 vcc, s5, v11
    s_and_saveexec_b64 s[6:7], vcc
    buffer_store_dword v26, v10, s[36:39], 0 offen offset:128
    s_mov_b64 exec, s[6:7]
    v_add_u32 v11, 3, v9
    v_cmp_gt_u32 vcc, s5, v11
    s_and_saveexec_b64 s[6:7], vcc
    buffer_store_dword v27, v10, s[36:39], 0 offen offset:192
    s_mov_b64 exec, s[6:7]
    s_endpgm
K1_LN:
    s_mov_b32 s36, s8
    s_and_b32 s37, s9, 0xffff
    s_mov_b32 s38, 2097152
    s_mov_b32 s39, 0x00020000
    s_add_u32 s40, s32, 0
    s_addc_u32 s41, s33, 0
    s_and_b32 s41, s41, 0xffff
    s_mov_b32 s42, 2162688
    s_mov_b32 s43, 0x00020000
    s_add_u32 s44, s32, 2359296
    s_addc_u32 s45, s33, 0
    s_and_b32 s45, s45, 0xffff
    s_mov_b32 s46, 2162688
    s_mov_b32 s47, 0x00020000
    s_sub_u32 s4, s2, 512
    s_lshl_b32 s4, s4, 5
    s_lshl_b32 s5, s3, 3
    s_add_u32 s4, s4, s5
    s_lshl_b32 s5, s4, 10
    v_lshlrev_b32 v2, 4, v1
    v_add_u32 v2, s5, v2
    buffer_load_dwordx4 v[16:19], v2, s[36:39], 0 offen
    v_add_u32 v2, 0x400, v2
    buffer_load_dwordx4 v[20:23], v2, s[36:39], 0 offen
    v_add_u32 v2, 0x400, v2
    buffer_load_dwordx4 v[24:27], v2, s[36:39], 0 offen
    v_add_u32 v2, 0x400, v2
    buffer_load_dwordx4 v[28:31], v2, s[36:39], 0 offen
    v_add_u32 v2, 0x400, v2
    buffer_load_dwordx4 v[32:35], v2, s[36:39], 0 offen
    v_add_u32 v2, 0x400, v2
    buffer_load_dwordx4 v[36:39], v2, s[36:39], 0 offen
    v_add_u32 v2, 0x400, v2
    buffer_load_dwordx4 v[40:43], v2, s[36:39], 0 offen
    v_add_u32 v2, 0x400, v2
    buffer_load_dwordx4 v[44:47], v2, s[36:39], 0 offen
    v_add_u32 v2, 0x400, v2
    s_waitcnt vmcnt(0)
    v_lshlrev_b32 v48, 16, v16
    v_and_b32 v49, 0xffff0000, v16
    v_lshlrev_b32 v50, 16, v17
    v_and_b32 v51, 0xffff0000, v17
    v_lshlrev_b32 v52, 16, v18
    v_and_b32 v53, 0xffff0000, v18
    v_lshlrev_b32 v54, 16, v19
    v_and_b32 v55, 0xffff0000, v19
    v_lshlrev_b32 v56, 16, v20
    v_and_b32 v57, 0xffff0000, v20
    v_lshlrev_b32 v58, 16, v21
    v_and_b32 v59, 0xffff0000, v21
    v_lshlrev_b32 v60, 16, v22
    v_and_b32 v61, 0xffff0000, v22
    v_lshlrev_b32 v62, 16, v23
    v_and_b32 v63, 0xffff0000, v23
    v_lshlrev_b32 v64, 16, v24
    v_and_b32 v65, 0xffff0000, v24
    v_lshlrev_b32 v66, 16, v25
    v_and_b32 v67, 0xffff0000, v25
    v_lshlrev_b32 v68, 16, v26
    v_and_b32 v69, 0xffff0000, v26
    v_lshlrev_b32 v70, 16, v27
    v_and_b32 v71, 0xffff0000, v27
    v_lshlrev_b32 v72, 16, v28
    v_and_b32 v73, 0xffff0000, v28
    v_lshlrev_b32 v74, 16, v29
    v_and_b32 v75, 0xffff0000, v29
    v_lshlrev_b32 v76, 16, v30
    v_and_b32 v77, 0xffff0000, v30
    v_lshlrev_b32 v78, 16, v31
    v_and_b32 v79, 0xffff0000, v31
    v_lshlrev_b32 v80, 16, v32
    v_and_b32 v81, 0xffff0000, v32
    v_lshlrev_b32 v82, 16, v33
    v_and_b32 v83, 0xffff0000, v33
    v_lshlrev_b32 v84, 16, v34
    v_and_b32 v85, 0xffff0000, v34
    v_lshlrev_b32 v86, 16, v35
    v_and_b32 v87, 0xffff0000, v35
    v_lshlrev_b32 v88, 16, v36
    v_and_b32 v89, 0xffff0000, v36
    v_lshlrev_b32 v90, 16, v37
    v_and_b32 v91, 0xffff0000, v37
    v_lshlrev_b32 v92, 16, v38
    v_and_b32 v93, 0xffff0000, v38
    v_lshlrev_b32 v94, 16, v39
    v_and_b32 v95, 0xffff0000, v39
    v_lshlrev_b32 v96, 16, v40
    v_and_b32 v97, 0xffff0000, v40
    v_lshlrev_b32 v98, 16, v41
    v_and_b32 v99, 0xffff0000, v41
    v_lshlrev_b32 v100, 16, v42
    v_and_b32 v101, 0xffff0000, v42
    v_lshlrev_b32 v102, 16, v43
    v_and_b32 v103, 0xffff0000, v43
    v_lshlrev_b32 v104, 16, v44
    v_and_b32 v105, 0xffff0000, v44
    v_lshlrev_b32 v106, 16, v45
    v_and_b32 v107, 0xffff0000, v45
    v_lshlrev_b32 v108, 16, v46
    v_and_b32 v109, 0xffff0000, v46
    v_lshlrev_b32 v110, 16, v47
    v_and_b32 v111, 0xffff0000, v47
    v_add_f32 v8, v48, v49
    v_add_f32 v9, v56, v57
    v_add_f32 v10, v64, v65
    v_add_f32 v11, v72, v73
    v_add_f32 v12, v80, v81
    v_add_f32 v13, v88, v89
    v_add_f32 v14, v96, v97
    v_add_f32 v15, v104, v105
    v_add_f32 v8, v8, v50
    v_add_f32 v9, v9, v58
    v_add_f32 v10, v10, v66
    v_add_f32 v11, v11, v74
    v_add_f32 v12, v12, v82
    v_add_f32 v13, v13, v90
    v_add_f32 v14, v14, v98
    v_add_f32 v15, v15, v106
    v_add_f32 v8, v8, v51
    v_add_f32 v9, v9, v59
    v_add_f32 v10, v10, v67
    v_add_f32 v11, v11, v75
    v_add_f32 v12, v12, v83
    v_add_f32 v13, v13, v91
    v_add_f32 v14, v14, v99
    v_add_f32 v15, v15, v107
    v_add_f32 v8, v8, v52
    v_add_f32 v9, v9, v60
    v_add_f32 v10, v10, v68
    v_add_f32 v11, v11, v76
    v_add_f32 v12, v12, v84
    v_add_f32 v13, v13, v92
    v_add_f32 v14, v14, v100
    v_add_f32 v15, v15, v108
    v_add_f32 v8, v8, v53
    v_add_f32 v9, v9, v61
    v_add_f32 v10, v10, v69
    v_add_f32 v11, v11, v77
    v_add_f32 v12, v12, v85
    v_add_f32 v13, v13, v93
    v_add_f32 v14, v14, v101
    v_add_f32 v15, v15, v109
    v_add_f32 v8, v8, v54
    v_add_f32 v9, v9, v62
    v_add_f32 v10, v10, v70
    v_add_f32 v11, v11, v78
    v_add_f32 v12, v12, v86
    v_add_f32 v13, v13, v94
    v_add_f32 v14, v14, v102
    v_add_f32 v15, v15, v110
    v_add_f32 v8, v8, v55
    v_add_f32 v9, v9, v63
    v_add_f32 v10, v10, v71
    v_add_f32 v11, v11, v79
    v_add_f32 v12, v12, v87
    v_add_f32 v13, v13, v95
    v_add_f32 v14, v14, v103
    v_add_f32 v15, v15, v111
    s_mov_b32 s8, 33792
    v_mul_lo_u32 v2, v1, s8
    s_lshl_b32 s5, s4, 1
    v_add_u32 v2, s5, v2
    v_mov_b32 v3, v2
    v_cvt_pk_bf16_f32 v112, v48, v56
    v_cvt_pk_bf16_f32 v113, v64, v72
    v_cvt_pk_bf16_f32 v114, v80, v88
    v_cvt_pk_bf16_f32 v115, v96, v104
    buffer_store_dwordx4 v[112:115], v3, s[44:47], 0 offen
    v_add_u32 v3, 4224, v3
    v_cvt_pk_bf16_f32 v116, v49, v57
    v_cvt_pk_bf16_f32 v117, v65, v73
    v_cvt_pk_bf16_f32 v118, v81, v89
    v_cvt_pk_bf16_f32 v119, v97, v105
    buffer_store_dwordx4 v[116:119], v3, s[44:47], 0 offen
    v_add_u32 v3, 4224, v3
    v_cvt_pk_bf16_f32 v120, v50, v58
    v_cvt_pk_bf16_f32 v121, v66, v74
    v_cvt_pk_bf16_f32 v122, v82, v90
    v_cvt_pk_bf16_f32 v123, v98, v106
    buffer_store_dwordx4 v[120:123], v3, s[44:47], 0 offen
    v_add_u32 v3, 4224, v3
    v_cvt_pk_bf16_f32 v124, v51, v59
    v_cvt_pk_bf16_f32 v125, v67, v75
    v_cvt_pk_bf16_f32 v126, v83, v91
    v_cvt_pk_bf16_f32 v127, v99, v107
    buffer_store_dwordx4 v[124:127], v3, s[44:47], 0 offen
    v_add_u32 v3, 4224, v3
    v_cvt_pk_bf16_f32 v112, v52, v60
    v_cvt_pk_bf16_f32 v113, v68, v76
    v_cvt_pk_bf16_f32 v114, v84, v92
    v_cvt_pk_bf16_f32 v115, v100, v108
    buffer_store_dwordx4 v[112:115], v3, s[44:47], 0 offen
    v_add_u32 v3, 4224, v3
    v_cvt_pk_bf16_f32 v116, v53, v61
    v_cvt_pk_bf16_f32 v117, v69, v77
    v_cvt_pk_bf16_f32 v118, v85, v93
    v_cvt_pk_bf16_f32 v119, v101, v109
    buffer_store_dwordx4 v[116:119], v3, s[44:47], 0 offen
    v_add_u32 v3, 4224, v3
    v_cvt_pk_bf16_f32 v120, v54, v62
    v_cvt_pk_bf16_f32 v121, v70, v78
    v_cvt_pk_bf16_f32 v122, v86, v94
    v_cvt_pk_bf16_f32 v123, v102, v110
    buffer_store_dwordx4 v[120:123], v3, s[44:47], 0 offen
    v_add_u32 v3, 4224, v3
    v_cvt_pk_bf16_f32 v124, v55, v63
    v_cvt_pk_bf16_f32 v125, v71, v79
    v_cvt_pk_bf16_f32 v126, v87, v95
    v_cvt_pk_bf16_f32 v127, v103, v111
    buffer_store_dwordx4 v[124:127], v3, s[44:47], 0 offen
    v_add_u32 v3, 4224, v3
    s_nop 1
    v_add_f32_dpp v8, v8, v8 row_shr:1 row_mask:0xf bank_mask:0xf bound_ctrl:0
    v_add_f32_dpp v9, v9, v9 row_shr:1 row_mask:0xf bank_mask:0xf bound_ctrl:0
    v_add_f32_dpp v10, v10, v10 row_shr:1 row_mask:0xf bank_mask:0xf bound_ctrl:0
    v_add_f32_dpp v11, v11, v11 row_shr:1 row_mask:0xf bank_mask:0xf bound_ctrl:0
    v_add_f32_dpp v12, v12, v12 row_shr:1 row_mask:0xf bank_mask:0xf bound_ctrl:0
    v_add_f32_dpp v13, v13, v13 row_shr:1 row_mask:0xf bank_mask:0xf bound_ctrl:0
    v_add_f32_dpp v14, v14, v14 row_shr:1 row_mask:0xf bank_mask:0xf bound_ctrl:0
    v_add_f32_dpp v15, v15, v15 row_shr:1 row_mask:0xf bank_mask:0xf bound_ctrl:0
    s_nop 1
    v_add_f32_dpp v8, v8, v8 row_shr:2 row_mask:0xf bank_mask:0xf bound_ctrl:0
    v_add_f32_dpp v9, v9, v9 row_shr:2 row_mask:0xf bank_mask:0xf bound_ctrl:0
    v_add_f32_dpp v10, v10, v10 row_shr:2 row_mask:0xf bank_mask:0xf bound_ctrl:0
    v_add_f32_dpp v11, v11, v11 row_shr:2 row_mask:0xf bank_mask:0xf bound_ctrl:0
    v_add_f32_dpp v12, v12, v12 row_shr:2 row_mask:0xf bank_mask:0xf bound_ctrl:0
    v_add_f32_dpp v13, v13, v13 row_shr:2 row_mask:0xf bank_mask:0xf bound_ctrl:0
    v_add_f32_dpp v14, v14, v14 row_shr:2 row_mask:0xf bank_mask:0xf bound_ctrl:0
    v_add_f32_dpp v15, v15, v15 row_shr:2 row_mask:0xf bank_mask:0xf bound_ctrl:0
    s_nop 1
    v_add_f32_dpp v8, v8, v8 row_shr:4 row_mask:0xf bank_mask:0xf bound_ctrl:0
    v_add_f32_dpp v9, v9, v9 row_shr:4 row_mask:0xf bank_mask:0xf bound_ctrl:0
    v_add_f32_dpp v10, v10, v10 row_shr:4 row_mask:0xf bank_mask:0xf bound_ctrl:0
    v_add_f32_dpp v11, v11, v11 row_shr:4 row_mask:0xf bank_mask:0xf bound_ctrl:0
    v_add_f32_dpp v12, v12, v12 row_shr:4 row_mask:0xf bank_mask:0xf bound_ctrl:0
    v_add_f32_dpp v13, v13, v13 row_shr:4 row_mask:0xf bank_mask:0xf bound_ctrl:0
    v_add_f32_dpp v14, v14, v14 row_shr:4 row_mask:0xf bank_mask:0xf bound_ctrl:0
    v_add_f32_dpp v15, v15, v15 row_shr:4 row_mask:0xf bank_mask:0xf bound_ctrl:0
    s_nop 1
    v_add_f32_dpp v8, v8, v8 row_shr:8 row_mask:0xf bank_mask:0xf bound_ctrl:0
    v_add_f32_dpp v9, v9, v9 row_shr:8 row_mask:0xf bank_mask:0xf bound_ctrl:0
    v_add_f32_dpp v10, v10, v10 row_shr:8 row_mask:0xf bank_mask:0xf bound_ctrl:0
    v_add_f32_dpp v11, v11, v11 row_shr:8 row_mask:0xf bank_mask:0xf bound_ctrl:0
    v_add_f32_dpp v12, v12, v12 row_shr:8 row_mask:0xf bank_mask:0xf bound_ctrl:0
    v_add_f32_dpp v13, v13, v13 row_shr:8 row_mask:0xf bank_mask:0xf bound_ctrl:0
    v_add_f32_dpp v14, v14, v14 row_shr:8 row_mask:0xf bank_mask:0xf bound_ctrl:0
    v_add_f32_dpp v15, v15, v15 row_shr:8 row_mask:0xf bank_mask:0xf bound_ctrl:0
    s_nop 1
    v_add_f32_dpp v8, v8, v8 row_bcast:15 row_mask:0xa bank_mask:0xf
    v_add_f32_dpp v9, v9, v9 row_bcast:15 row_mask:0xa bank_mask:0xf
    v_add_f32_dpp v10, v10, v10 row_bcast:15 row_mask:0xa bank_mask:0xf
    v_add_f32_dpp v11, v11, v11 row_bcast:15 row_mask:0xa bank_mask:0xf
    v_add_f32_dpp v12, v12, v12 row_bcast:15 row_mask:0xa bank_mask:0xf
    v_add_f32_dpp v13, v13, v13 row_bcast:15 row_mask:0xa bank_mask:0xf
    v_add_f32_dpp v14, v14, v14 row_bcast:15 row_mask:0xa bank_mask:0xf
    v_add_f32_dpp v15, v15, v15 row_bcast:15 row_mask:0xa bank_mask:0xf
    s_nop 1
    v_add_f32_dpp v8, v8, v8 row_bcast:31 row_mask:0xc bank_mask:0xf
    v_add_f32_dpp v9, v9, v9 row_bcast:31 row_mask:0xc bank_mask:0xf
    v_add_f32_dpp v10, v10, v10 row_bcast:31 row_mask:0xc bank_mask:0xf
    v_add_f32_dpp v11, v11, v11 row_bcast:31 row_mask:0xc bank_mask:0xf
    v_add_f32_dpp v12, v12, v12 row_bcast:31 row_mask:0xc bank_mask:0xf
    v_add_f32_dpp v13, v13, v13 row_bcast:31 row_mask:0xc bank_mask:0xf
    v_add_f32_dpp v14, v14, v14 row_bcast:31 row_mask:0xc bank_mask:0xf
    v_add_f32_dpp v15, v15, v15 row_bcast:31 row_mask:0xc bank_mask:0xf
    s_nop 1
    v_readlane_b32 s48, v8, 63
    v_readlane_b32 s49, v9, 63
    v_readlane_b32 s50, v10, 63
    v_readlane_b32 s51, v11, 63
    v_readlane_b32 s52, v12, 63
    v_readlane_b32 s53, v13, 63
    v_readlane_b32 s54, v14, 63
    v_readlane_b32 s55, v15, 63
    s_nop 3
    s_mov_b32 s6, 0x3b000000
    v_mov_b32 v16, s48
    v_mov_b32 v17, s49
    v_mov_b32 v18, s50
    v_mov_b32 v19, s51
    v_mov_b32 v20, s52
    v_mov_b32 v21, s53
    v_mov_b32 v22, s54
    v_mov_b32 v23, s55
    v_mul_f32 v16, s6, v16
    v_mul_f32 v17, s6, v17
    v_mul_f32 v18, s6, v18
    v_mul_f32 v19, s6, v19
    v_mul_f32 v20, s6, v20
    v_mul_f32 v21, s6, v21
    v_mul_f32 v22, s6, v22
    v_mul_f32 v23, s6, v23
    v_mov_b32 v8, 0
    v_mov_b32 v9, 0
    v_mov_b32 v10, 0
    v_mov_b32 v11, 0
    v_mov_b32 v12, 0
    v_mov_b32 v13, 0
    v_mov_b32 v14, 0
    v_mov_b32 v15, 0
    v_sub_f32 v24, v48, v16
    v_sub_f32 v25, v56, v17
    v_sub_f32 v26, v64, v18
    v_sub_f32 v27, v72, v19
    v_sub_f32 v28, v80, v20
    v_sub_f32 v29, v88, v21
    v_sub_f32 v30, v96, v22
    v_sub_f32 v31, v104, v23
    v_fma_f32 v8, v24, v24, v8
    v_fma_f32 v9, v25, v25, v9
    v_fma_f32 v10, v26, v26, v10
    v_fma_f32 v11, v27, v27, v11
    v_fma_f32 v12, v28, v28, v12
    v_fma_f32 v13, v29, v29, v13
    v_fma_f32 v14, v30, v30, v14
    v_fma_f32 v15, v31, v31, v15
    v_sub_f32 v24, v49, v16
    v_sub_f32 v25, v57, v17
    v_sub_f32 v26, v65, v18
    v_sub_f32 v27, v73, v19
    v_sub_f32 v28, v81, v20
    v_sub_f32 v29, v89, v21
    v_sub_f32 v30, v97, v22
    v_sub_f32 v31, v105, v23
    v_fma_f32 v8, v24, v24, v8
    v_fma_f32 v9, v25, v25, v9
    v_fma_f32 v10, v26, v26, v10
    v_fma_f32 v11, v27, v27, v11
    v_fma_f32 v12, v28, v28, v12
    v_fma_f32 v13, v29, v29, v13
    v_fma_f32 v14, v30, v30, v14
    v_fma_f32 v15, v31, v31, v15
    v_sub_f32 v24, v50, v16
    v_sub_f32 v25, v58, v17
    v_sub_f32 v26, v66, v18
    v_sub_f32 v27, v74, v19
    v_sub_f32 v28, v82, v20
    v_sub_f32 v29, v90, v21
    v_sub_f32 v30, v98, v22
    v_sub_f32 v31, v106, v23
    v_fma_f32 v8, v24, v24, v8
    v_fma_f32 v9, v25, v25, v9
    v_fma_f32 v10, v26, v26, v10
    v_fma_f32 v11, v27, v27, v11
    v_fma_f32 v12, v28, v28, v12
    v_fma_f32 v13, v29, v29, v13
    v_fma_f32 v14, v30, v30, v14
    v_fma_f32 v15, v31, v31, v15
    v_sub_f32 v24, v51, v16
    v_sub_f32 v25, v59, v17
    v_sub_f32 v26, v67, v18
    v_sub_f32 v27, v75, v19
    v_sub_f32 v28, v83, v20
    v_sub_f32 v29, v91, v21
    v_sub_f32 v30, v99, v22
    v_sub_f32 v31, v107, v23
    v_fma_f32 v8, v24, v24, v8
    v_fma_f32 v9, v25, v25, v9
    v_fma_f32 v10, v26, v26, v10
    v_fma_f32 v11, v27, v27, v11
    v_fma_f32 v12, v28, v28, v12
    v_fma_f32 v13, v29, v29, v13
    v_fma_f32 v14, v30, v30, v14
    v_fma_f32 v15, v31, v31, v15
    v_sub_f32 v24, v52, v16
    v_sub_f32 v25, v60, v17
    v_sub_f32 v26, v68, v18
    v_sub_f32 v27, v76, v19
    v_sub_f32 v28, v84, v20
    v_sub_f32 v29, v92, v21
    v_sub_f32 v30, v100, v22
    v_sub_f32 v31, v108, v23
    v_fma_f32 v8, v24, v24, v8
    v_fma_f32 v9, v25, v25, v9
    v_fma_f32 v10, v26, v26, v10
    v_fma_f32 v11, v27, v27, v11
    v_fma_f32 v12, v28, v28, v12
    v_fma_f32 v13, v29, v29, v13
    v_fma_f32 v14, v30, v30, v14
    v_fma_f32 v15, v31, v31, v15
    v_sub_f32 v24, v53, v16
    v_sub_f32 v25, v61, v17
    v_sub_f32 v26, v69, v18
    v_sub_f32 v27, v77, v19
    v_sub_f32 v28, v85, v20
    v_sub_f32 v29, v93, v21
    v_sub_f32 v30, v101, v22
    v_sub_f32 v31, v109, v23
    v_fma_f32 v8, v24, v24, v8
    v_fma_f32 v9, v25, v25, v9
    v_fma_f32 v10, v26, v26, v10
    v_fma_f32 v11, v27, v27, v11
    v_fma_f32 v12, v28, v28, v12
    v_fma_f32 v13, v29, v29, v13
    v_fma_f32 v14, v30, v30, v14
    v_fma_f32 v15, v31, v31, v15
    v_sub_f32 v24, v54, v16
    v_sub_f32 v25, v62, v17
    v_sub_f32 v26, v70, v18
    v_sub_f32 v27, v78, v19
    v_sub_f32 v28, v86, v20
    v_sub_f32 v29, v94, v21
    v_sub_f32 v30, v102, v22
    v_sub_f32 v31, v110, v23
    v_fma_f32 v8, v24, v24, v8
    v_fma_f32 v9, v25, v25, v9
    v_fma_f32 v10, v26, v26, v10
    v_fma_f32 v11, v27, v27, v11
    v_fma_f32 v12, v28, v28, v12
    v_fma_f32 v13, v29, v29, v13
    v_fma_f32 v14, v30, v30, v14
    v_fma_f32 v15, v31, v31, v15
    v_sub_f32 v24, v55, v16
    v_sub_f32 v25, v63, v17
    v_sub_f32 v26, v71, v18
    v_sub_f32 v27, v79, v19
    v_sub_f32 v28, v87, v20
    v_sub_f32 v29, v95, v21
    v_sub_f32 v30, v103, v22
    v_sub_f32 v31, v111, v23
    v_fma_f32 v8, v24, v24, v8
    v_fma_f32 v9, v25, v25, v9
    v_fma_f32 v10, v26, v26, v10
    v_fma_f32 v11, v27, v27, v11
    v_fma_f32 v12, v28, v28, v12
    v_fma_f32 v13, v29, v29, v13
    v_fma_f32 v14, v30, v30, v14
    v_fma_f32 v15, v31, v31, v15
    s_nop 1
    v_add_f32_dpp v8, v8, v8 row_shr:1 row_mask:0xf bank_mask:0xf bound_ctrl:0
    v_add_f32_dpp v9, v9, v9 row_shr:1 row_mask:0xf bank_mask:0xf bound_ctrl:0
    v_add_f32_dpp v10, v10, v10 row_shr:1 row_mask:0xf bank_mask:0xf bound_ctrl:0
    v_add_f32_dpp v11, v11, v11 row_shr:1 row_mask:0xf bank_mask:0xf bound_ctrl:0
    v_add_f32_dpp v12, v12, v12 row_shr:1 row_mask:0xf bank_mask:0xf bound_ctrl:0
    v_add_f32_dpp v13, v13, v13 row_shr:1 row_mask:0xf bank_mask:0xf bound_ctrl:0
    v_add_f32_dpp v14, v14, v14 row_shr:1 row_mask:0xf bank_mask:0xf bound_ctrl:0
    v_add_f32_dpp v15, v15, v15 row_shr:1 row_mask:0xf bank_mask:0xf bound_ctrl:0
    s_nop 1
    v_add_f32_dpp v8, v8, v8 row_shr:2 row_mask:0xf bank_mask:0xf bound_ctrl:0
    v_add_f32_dpp v9, v9, v9 row_shr:2 row_mask:0xf bank_mask:0xf bound_ctrl:0
    v_add_f32_dpp v10, v10, v10 row_shr:2 row_mask:0xf bank_mask:0xf bound_ctrl:0
    v_add_f32_dpp v11, v11, v11 row_shr:2 row_mask:0xf bank_mask:0xf bound_ctrl:0
    v_add_f32_dpp v12, v12, v12 row_shr:2 row_mask:0xf bank_mask:0xf bound_ctrl:0
    v_add_f32_dpp v13, v13, v13 row_shr:2 row_mask:0xf bank_mask:0xf bound_ctrl:0
    v_add_f32_dpp v14, v14, v14 row_shr:2 row_mask:0xf bank_mask:0xf bound_ctrl:0
    v_add_f32_dpp v15, v15, v15 row_shr:2 row_mask:0xf bank_mask:0xf bound_ctrl:0
    s_nop 1
    v_add_f32_dpp v8, v8, v8 row_shr:4 row_mask:0xf bank_mask:0xf bound_ctrl:0
    v_add_f32_dpp v9, v9, v9 row_shr:4 row_mask:0xf bank_mask:0xf bound_ctrl:0
    v_add_f32_dpp v10, v10, v10 row_shr:4 row_mask:0xf bank_mask:0xf bound_ctrl:0
    v_add_f32_dpp v11, v11, v11 row_shr:4 row_mask:0xf bank_mask:0xf bound_ctrl:0
    v_add_f32_dpp v12, v12, v12 row_shr:4 row_mask:0xf bank_mask:0xf bound_ctrl:0
    v_add_f32_dpp v13, v13, v13 row_shr:4 row_mask:0xf bank_mask:0xf bound_ctrl:0
    v_add_f32_dpp v14, v14, v14 row_shr:4 row_mask:0xf bank_mask:0xf bound_ctrl:0
    v_add_f32_dpp v15, v15, v15 row_shr:4 row_mask:0xf bank_mask:0xf bound_ctrl:0
    s_nop 1
    v_add_f32_dpp v8, v8, v8 row_shr:8 row_mask:0xf bank_mask:0xf bound_ctrl:0
    v_add_f32_dpp v9, v9, v9 row_shr:8 row_mask:0xf bank_mask:0xf bound_ctrl:0
    v_add_f32_dpp v10, v10, v10 row_shr:8 row_mask:0xf bank_mask:0xf bound_ctrl:0
    v_add_f32_dpp v11, v11, v11 row_shr:8 row_mask:0xf bank_mask:0xf bound_ctrl:0
    v_add_f32_dpp v12, v12, v12 row_shr:8 row_mask:0xf bank_mask:0xf bound_ctrl:0
    v_add_f32_dpp v13, v13, v13 row_shr:8 row_mask:0xf bank_mask:0xf bound_ctrl:0
    v_add_f32_dpp v14, v14, v14 row_shr:8 row_mask:0xf bank_mask:0xf bound_ctrl:0
    v_add_f32_dpp v15, v15, v15 row_shr:8 row_mask:0xf bank_mask:0xf bound_ctrl:0
    s_nop 1
    v_add_f32_dpp v8, v8, v8 row_bcast:15 row_mask:0xa bank_mask:0xf
    v_add_f32_dpp v9, v9, v9 row_bcast:15 row_mask:0xa bank_mask:0xf
    v_add_f32_dpp v10, v10, v10 row_bcast:15 row_mask:0xa bank_mask:0xf
    v_add_f32_dpp v11, v11, v11 row_bcast:15 row_mask:0xa bank_mask:0xf
    v_add_f32_dpp v12, v12, v12 row_bcast:15 row_mask:0xa bank_mask:0xf
    v_add_f32_dpp v13, v13, v13 row_bcast:15 row_mask:0xa bank_mask:0xf
    v_add_f32_dpp v14, v14, v14 row_bcast:15 row_mask:0xa bank_mask:0xf
    v_add_f32_dpp v15, v15, v15 row_bcast:15 row_mask:0xa bank_mask:0xf
    s_nop 1
    v_add_f32_dpp v8, v8, v8 row_bcast:31 row_mask:0xc bank_mask:0xf
    v_add_f32_dpp v9, v9, v9 row_bcast:31 row_mask:0xc bank_mask:0xf
    v_add_f32_dpp v10, v10, v10 row_bcast:31 row_mask:0xc bank_mask:0xf
    v_add_f32_dpp v11, v11, v11 row_bcast:31 row_mask:0xc bank_mask:0xf
    v_add_f32_dpp v12, v12, v12 row_bcast:31 row_mask:0xc bank_mask:0xf
    v_add_f32_dpp v13, v13, v13 row_bcast:31 row_mask:0xc bank_mask:0xf
    v_add_f32_dpp v14, v14, v14 row_bcast:31 row_mask:0xc bank_mask:0xf
    v_add_f32_dpp v15, v15, v15 row_bcast:31 row_mask:0xc bank_mask:0xf
    s_nop 1
    v_readlane_b32 s56, v8, 63
    v_readlane_b32 s57, v9, 63
    v_readlane_b32 s58, v10, 63
    v_readlane_b32 s59, v11, 63
    v_readlane_b32 s60, v12, 63
    v_readlane_b32 s61, v13, 63
    v_readlane_b32 s62, v14, 63
    v_readlane_b32 s63, v15, 63
    s_nop 3
    s_mov_b32 s7, 0x3727c5ac
    v_mov_b32 v8, s56
    v_mov_b32 v9, s57
    v_mov_b32 v10, s58
    v_mov_b32 v11, s59
    v_mov_b32 v12, s60
    v_mov_b32 v13, s61
    v_mov_b32 v14, s62
    v_mov_b32 v15, s63
    v_mul_f32 v8, s6, v8
    v_cvt_pk_bf16_f32 v8, v8, v8
    v_and_b32 v8, 0xffff0000, v8
    v_add_f32 v8, s7, v8
    v_cvt_pk_bf16_f32 v8, v8, v8
    v_and_b32 v8, 0xffff0000, v8
    v_sqrt_f32 v8, v8
    s_nop 0
    v_cvt_pk_bf16_f32 v8, v8, v8
    v_and_b32 v8, 0xffff0000, v8
    v_rcp_f32 v8, v8
    v_cvt_pk_bf16_f32 v16, v16, v16
    v_and_b32 v16, 0xffff0000, v16

    v_mul_f32 v9, s6, v9
    v_cvt_pk_bf16_f32 v9, v9, v9
    v_and_b32 v9, 0xffff0000, v9
    v_add_f32 v9, s7, v9
    v_cvt_pk_bf16_f32 v9, v9, v9
    v_and_b32 v9, 0xffff0000, v9
    v_sqrt_f32 v9, v9
    s_nop 0
    v_cvt_pk_bf16_f32 v9, v9, v9
    v_and_b32 v9, 0xffff0000, v9
    v_rcp_f32 v9, v9
    v_cvt_pk_bf16_f32 v17, v17, v17
    v_and_b32 v17, 0xffff0000, v17

    v_mul_f32 v10, s6, v10
    v_cvt_pk_bf16_f32 v10, v10, v10
    v_and_b32 v10, 0xffff0000, v10
    v_add_f32 v10, s7, v10
    v_cvt_pk_bf16_f32 v10, v10, v10
    v_and_b32 v10, 0xffff0000, v10
    v_sqrt_f32 v10, v10
    s_nop 0
    v_cvt_pk_bf16_f32 v10, v10, v10
    v_and_b32 v10, 0xffff0000, v10
    v_rcp_f32 v10, v10
    v_cvt_pk_bf16_f32 v18, v18, v18
    v_and_b32 v18, 0xffff0000, v18

    v_mul_f32 v11, s6, v11
    v_cvt_pk_bf16_f32 v11, v11, v11
    v_and_b32 v11, 0xffff0000, v11
    v_add_f32 v11, s7, v11
    v_cvt_pk_bf16_f32 v11, v11, v11
    v_and_b32 v11, 0xffff0000, v11
    v_sqrt_f32 v11, v11
    s_nop 0
    v_cvt_pk_bf16_f32 v11, v11, v11
    v_and_b32 v11, 0xffff0000, v11
    v_rcp_f32 v11, v11
    v_cvt_pk_bf16_f32 v19, v19, v19
    v_and_b32 v19, 0xffff0000, v19

    v_mul_f32 v12, s6, v12
    v_cvt_pk_bf16_f32 v12, v12, v12
    v_and_b32 v12, 0xffff0000, v12
    v_add_f32 v12, s7, v12
    v_cvt_pk_bf16_f32 v12, v12, v12
    v_and_b32 v12, 0xffff0000, v12
    v_sqrt_f32 v12, v12
    s_nop 0
    v_cvt_pk_bf16_f32 v12, v12, v12
    v_and_b32 v12, 0xffff0000, v12
    v_rcp_f32 v12, v12
    v_cvt_pk_bf16_f32 v20, v20, v20
    v_and_b32 v20, 0xffff0000, v20

    v_mul_f32 v13, s6, v13
    v_cvt_pk_bf16_f32 v13, v13, v13
    v_and_b32 v13, 0xffff0000, v13
    v_add_f32 v13, s7, v13
    v_cvt_pk_bf16_f32 v13, v13, v13
    v_and_b32 v13, 0xffff0000, v13
    v_sqrt_f32 v13, v13
    s_nop 0
    v_cvt_pk_bf16_f32 v13, v13, v13
    v_and_b32 v13, 0xffff0000, v13
    v_rcp_f32 v13, v13
    v_cvt_pk_bf16_f32 v21, v21, v21
    v_and_b32 v21, 0xffff0000, v21

    v_mul_f32 v14, s6, v14
    v_cvt_pk_bf16_f32 v14, v14, v14
    v_and_b32 v14, 0xffff0000, v14
    v_add_f32 v14, s7, v14
    v_cvt_pk_bf16_f32 v14, v14, v14
    v_and_b32 v14, 0xffff0000, v14
    v_sqrt_f32 v14, v14
    s_nop 0
    v_cvt_pk_bf16_f32 v14, v14, v14
    v_and_b32 v14, 0xffff0000, v14
    v_rcp_f32 v14, v14
    v_cvt_pk_bf16_f32 v22, v22, v22
    v_and_b32 v22, 0xffff0000, v22

    v_mul_f32 v15, s6, v15
    v_cvt_pk_bf16_f32 v15, v15, v15
    v_and_b32 v15, 0xffff0000, v15
    v_add_f32 v15, s7, v15
    v_cvt_pk_bf16_f32 v15, v15, v15
    v_and_b32 v15, 0xffff0000, v15
    v_sqrt_f32 v15, v15
    s_nop 0
    v_cvt_pk_bf16_f32 v15, v15, v15
    v_and_b32 v15, 0xffff0000, v15
    v_rcp_f32 v15, v15
    v_cvt_pk_bf16_f32 v23, v23, v23
    v_and_b32 v23, 0xffff0000, v23

    v_sub_f32 v48, v48, v16
    v_sub_f32 v49, v49, v16
    v_sub_f32 v50, v50, v16
    v_sub_f32 v51, v51, v16
    v_sub_f32 v52, v52, v16
    v_sub_f32 v53, v53, v16
    v_sub_f32 v54, v54, v16
    v_sub_f32 v55, v55, v16
    v_sub_f32 v56, v56, v17
    v_sub_f32 v57, v57, v17
    v_sub_f32 v58, v58, v17
    v_sub_f32 v59, v59, v17
    v_sub_f32 v60, v60, v17
    v_sub_f32 v61, v61, v17
    v_sub_f32 v62, v62, v17
    v_sub_f32 v63, v63, v17
    v_sub_f32 v64, v64, v18
    v_sub_f32 v65, v65, v18
    v_sub_f32 v66, v66, v18
    v_sub_f32 v67, v67, v18
    v_sub_f32 v68, v68, v18
    v_sub_f32 v69, v69, v18
    v_sub_f32 v70, v70, v18
    v_sub_f32 v71, v71, v18
    v_sub_f32 v72, v72, v19
    v_sub_f32 v73, v73, v19
    v_sub_f32 v74, v74, v19
    v_sub_f32 v75, v75, v19
    v_sub_f32 v76, v76, v19
    v_sub_f32 v77, v77, v19
    v_sub_f32 v78, v78, v19
    v_sub_f32 v79, v79, v19
    v_sub_f32 v80, v80, v20
    v_sub_f32 v81, v81, v20
    v_sub_f32 v82, v82, v20
    v_sub_f32 v83, v83, v20
    v_sub_f32 v84, v84, v20
    v_sub_f32 v85, v85, v20
    v_sub_f32 v86, v86, v20
    v_sub_f32 v87, v87, v20
    v_sub_f32 v88, v88, v21
    v_sub_f32 v89, v89, v21
    v_sub_f32 v90, v90, v21
    v_sub_f32 v91, v91, v21
    v_sub_f32 v92, v92, v21
    v_sub_f32 v93, v93, v21
    v_sub_f32 v94, v94, v21
    v_sub_f32 v95, v95, v21
    v_sub_f32 v96, v96, v22
    v_sub_f32 v97, v97, v22
    v_sub_f32 v98, v98, v22
    v_sub_f32 v99, v99, v22
    v_sub_f32 v100, v100, v22
    v_sub_f32 v101, v101, v22
    v_sub_f32 v102, v102, v22
    v_sub_f32 v103, v103, v22
    v_sub_f32 v104, v104, v23
    v_sub_f32 v105, v105, v23
    v_sub_f32 v106, v106, v23
    v_sub_f32 v107, v107, v23
    v_sub_f32 v108, v108, v23
    v_sub_f32 v109, v109, v23
    v_sub_f32 v110, v110, v23
    v_sub_f32 v111, v111, v23
    v_cvt_pk_bf16_f32 v48, v48, v48
    v_cvt_pk_bf16_f32 v49, v49, v49
    v_cvt_pk_bf16_f32 v50, v50, v50
    v_cvt_pk_bf16_f32 v51, v51, v51
    v_cvt_pk_bf16_f32 v52, v52, v52
    v_cvt_pk_bf16_f32 v53, v53, v53
    v_cvt_pk_bf16_f32 v54, v54, v54
    v_cvt_pk_bf16_f32 v55, v55, v55
    v_cvt_pk_bf16_f32 v56, v56, v56
    v_cvt_pk_bf16_f32 v57, v57, v57
    v_cvt_pk_bf16_f32 v58, v58, v58
    v_cvt_pk_bf16_f32 v59, v59, v59
    v_cvt_pk_bf16_f32 v60, v60, v60
    v_cvt_pk_bf16_f32 v61, v61, v61
    v_cvt_pk_bf16_f32 v62, v62, v62
    v_cvt_pk_bf16_f32 v63, v63, v63
    v_cvt_pk_bf16_f32 v64, v64, v64
    v_cvt_pk_bf16_f32 v65, v65, v65
    v_cvt_pk_bf16_f32 v66, v66, v66
    v_cvt_pk_bf16_f32 v67, v67, v67
    v_cvt_pk_bf16_f32 v68, v68, v68
    v_cvt_pk_bf16_f32 v69, v69, v69
    v_cvt_pk_bf16_f32 v70, v70, v70
    v_cvt_pk_bf16_f32 v71, v71, v71
    v_cvt_pk_bf16_f32 v72, v72, v72
    v_cvt_pk_bf16_f32 v73, v73, v73
    v_cvt_pk_bf16_f32 v74, v74, v74
    v_cvt_pk_bf16_f32 v75, v75, v75
    v_cvt_pk_bf16_f32 v76, v76, v76
    v_cvt_pk_bf16_f32 v77, v77, v77
    v_cvt_pk_bf16_f32 v78, v78, v78
    v_cvt_pk_bf16_f32 v79, v79, v79
    v_cvt_pk_bf16_f32 v80, v80, v80
    v_cvt_pk_bf16_f32 v81, v81, v81
    v_cvt_pk_bf16_f32 v82, v82, v82
    v_cvt_pk_bf16_f32 v83, v83, v83
    v_cvt_pk_bf16_f32 v84, v84, v84
    v_cvt_pk_bf16_f32 v85, v85, v85
    v_cvt_pk_bf16_f32 v86, v86, v86
    v_cvt_pk_bf16_f32 v87, v87, v87
    v_cvt_pk_bf16_f32 v88, v88, v88
    v_cvt_pk_bf16_f32 v89, v89, v89
    v_cvt_pk_bf16_f32 v90, v90, v90
    v_cvt_pk_bf16_f32 v91, v91, v91
    v_cvt_pk_bf16_f32 v92, v92, v92
    v_cvt_pk_bf16_f32 v93, v93, v93
    v_cvt_pk_bf16_f32 v94, v94, v94
    v_cvt_pk_bf16_f32 v95, v95, v95
    v_cvt_pk_bf16_f32 v96, v96, v96
    v_cvt_pk_bf16_f32 v97, v97, v97
    v_cvt_pk_bf16_f32 v98, v98, v98
    v_cvt_pk_bf16_f32 v99, v99, v99
    v_cvt_pk_bf16_f32 v100, v100, v100
    v_cvt_pk_bf16_f32 v101, v101, v101
    v_cvt_pk_bf16_f32 v102, v102, v102
    v_cvt_pk_bf16_f32 v103, v103, v103
    v_cvt_pk_bf16_f32 v104, v104, v104
    v_cvt_pk_bf16_f32 v105, v105, v105
    v_cvt_pk_bf16_f32 v106, v106, v106
    v_cvt_pk_bf16_f32 v107, v107, v107
    v_cvt_pk_bf16_f32 v108, v108, v108
    v_cvt_pk_bf16_f32 v109, v109, v109
    v_cvt_pk_bf16_f32 v110, v110, v110
    v_cvt_pk_bf16_f32 v111, v111, v111
    v_and_b32 v48, 0xffff0000, v48
    v_and_b32 v49, 0xffff0000, v49
    v_and_b32 v50, 0xffff0000, v50
    v_and_b32 v51, 0xffff0000, v51
    v_and_b32 v52, 0xffff0000, v52
    v_and_b32 v53, 0xffff0000, v53
    v_and_b32 v54, 0xffff0000, v54
    v_and_b32 v55, 0xffff0000, v55
    v_and_b32 v56, 0xffff0000, v56
    v_and_b32 v57, 0xffff0000, v57
    v_and_b32 v58, 0xffff0000, v58
    v_and_b32 v59, 0xffff0000, v59
    v_and_b32 v60, 0xffff0000, v60
    v_and_b32 v61, 0xffff0000, v61
    v_and_b32 v62, 0xffff0000, v62
    v_and_b32 v63, 0xffff0000, v63
    v_and_b32 v64, 0xffff0000, v64
    v_and_b32 v65, 0xffff0000, v65
    v_and_b32 v66, 0xffff0000, v66
    v_and_b32 v67, 0xffff0000, v67
    v_and_b32 v68, 0xffff0000, v68
    v_and_b32 v69, 0xffff0000, v69
    v_and_b32 v70, 0xffff0000, v70
    v_and_b32 v71, 0xffff0000, v71
    v_and_b32 v72, 0xffff0000, v72
    v_and_b32 v73, 0xffff0000, v73
    v_and_b32 v74, 0xffff0000, v74
    v_and_b32 v75, 0xffff0000, v75
    v_and_b32 v76, 0xffff0000, v76
    v_and_b32 v77, 0xffff0000, v77
    v_and_b32 v78, 0xffff0000, v78
    v_and_b32 v79, 0xffff0000, v79
    v_and_b32 v80, 0xffff0000, v80
    v_and_b32 v81, 0xffff0000, v81
    v_and_b32 v82, 0xffff0000, v82
    v_and_b32 v83, 0xffff0000, v83
    v_and_b32 v84, 0xffff0000, v84
    v_and_b32 v85, 0xffff0000, v85
    v_and_b32 v86, 0xffff0000, v86
    v_and_b32 v87, 0xffff0000, v87
    v_and_b32 v88, 0xffff0000, v88
    v_and_b32 v89, 0xffff0000, v89
    v_and_b32 v90, 0xffff0000, v90
    v_and_b32 v91, 0xffff0000, v91
    v_and_b32 v92, 0xffff0000, v92
    v_and_b32 v93, 0xffff0000, v93
    v_and_b32 v94, 0xffff0000, v94
    v_and_b32 v95, 0xffff0000, v95
    v_and_b32 v96, 0xffff0000, v96
    v_and_b32 v97, 0xffff0000, v97
    v_and_b32 v98, 0xffff0000, v98
    v_and_b32 v99, 0xffff0000, v99
    v_and_b32 v100, 0xffff0000, v100
    v_and_b32 v101, 0xffff0000, v101
    v_and_b32 v102, 0xffff0000, v102
    v_and_b32 v103, 0xffff0000, v103
    v_and_b32 v104, 0xffff0000, v104
    v_and_b32 v105, 0xffff0000, v105
    v_and_b32 v106, 0xffff0000, v106
    v_and_b32 v107, 0xffff0000, v107
    v_and_b32 v108, 0xffff0000, v108
    v_and_b32 v109, 0xffff0000, v109
    v_and_b32 v110, 0xffff0000, v110
    v_and_b32 v111, 0xffff0000, v111
    v_mul_f32 v48, v48, v8
    v_mul_f32 v49, v49, v8
    v_mul_f32 v50, v50, v8
    v_mul_f32 v51, v51, v8
    v_mul_f32 v52, v52, v8
    v_mul_f32 v53, v53, v8
    v_mul_f32 v54, v54, v8
    v_mul_f32 v55, v55, v8
    v_mul_f32 v56, v56, v9
    v_mul_f32 v57, v57, v9
    v_mul_f32 v58, v58, v9
    v_mul_f32 v59, v59, v9
    v_mul_f32 v60, v60, v9
    v_mul_f32 v61, v61, v9
    v_mul_f32 v62, v62, v9
    v_mul_f32 v63, v63, v9
    v_mul_f32 v64, v64, v10
    v_mul_f32 v65, v65, v10
    v_mul_f32 v66, v66, v10
    v_mul_f32 v67, v67, v10
    v_mul_f32 v68, v68, v10
    v_mul_f32 v69, v69, v10
    v_mul_f32 v70, v70, v10
    v_mul_f32 v71, v71, v10
    v_mul_f32 v72, v72, v11
    v_mul_f32 v73, v73, v11
    v_mul_f32 v74, v74, v11
    v_mul_f32 v75, v75, v11
    v_mul_f32 v76, v76, v11
    v_mul_f32 v77, v77, v11
    v_mul_f32 v78, v78, v11
    v_mul_f32 v79, v79, v11
    v_mul_f32 v80, v80, v12
    v_mul_f32 v81, v81, v12
    v_mul_f32 v82, v82, v12
    v_mul_f32 v83, v83, v12
    v_mul_f32 v84, v84, v12
    v_mul_f32 v85, v85, v12
    v_mul_f32 v86, v86, v12
    v_mul_f32 v87, v87, v12
    v_mul_f32 v88, v88, v13
    v_mul_f32 v89, v89, v13
    v_mul_f32 v90, v90, v13
    v_mul_f32 v91, v91, v13
    v_mul_f32 v92, v92, v13
    v_mul_f32 v93, v93, v13
    v_mul_f32 v94, v94, v13
    v_mul_f32 v95, v95, v13
    v_mul_f32 v96, v96, v14
    v_mul_f32 v97, v97, v14
    v_mul_f32 v98, v98, v14
    v_mul_f32 v99, v99, v14
    v_mul_f32 v100, v100, v14
    v_mul_f32 v101, v101, v14
    v_mul_f32 v102, v102, v14
    v_mul_f32 v103, v103, v14
    v_mul_f32 v104, v104, v15
    v_mul_f32 v105, v105, v15
    v_mul_f32 v106, v106, v15
    v_mul_f32 v107, v107, v15
    v_mul_f32 v108, v108, v15
    v_mul_f32 v109, v109, v15
    v_mul_f32 v110, v110, v15
    v_mul_f32 v111, v111, v15
    v_cvt_pk_bf16_f32 v112, v48, v56
    v_cvt_pk_bf16_f32 v113, v64, v72
    v_cvt_pk_bf16_f32 v114, v80, v88
    v_cvt_pk_bf16_f32 v115, v96, v104
    buffer_store_dwordx4 v[112:115], v2, s[40:43], 0 offen
    v_add_u32 v2, 4224, v2
    v_cvt_pk_bf16_f32 v116, v49, v57
    v_cvt_pk_bf16_f32 v117, v65, v73
    v_cvt_pk_bf16_f32 v118, v81, v89
    v_cvt_pk_bf16_f32 v119, v97, v105
    buffer_store_dwordx4 v[116:119], v2, s[40:43], 0 offen
    v_add_u32 v2, 4224, v2
    v_cvt_pk_bf16_f32 v120, v50, v58
    v_cvt_pk_bf16_f32 v121, v66, v74
    v_cvt_pk_bf16_f32 v122, v82, v90
    v_cvt_pk_bf16_f32 v123, v98, v106
    buffer_store_dwordx4 v[120:123], v2, s[40:43], 0 offen
    v_add_u32 v2, 4224, v2
    v_cvt_pk_bf16_f32 v124, v51, v59
    v_cvt_pk_bf16_f32 v125, v67, v75
    v_cvt_pk_bf16_f32 v126, v83, v91
    v_cvt_pk_bf16_f32 v127, v99, v107
    buffer_store_dwordx4 v[124:127], v2, s[40:43], 0 offen
    v_add_u32 v2, 4224, v2
    v_cvt_pk_bf16_f32 v112, v52, v60
    v_cvt_pk_bf16_f32 v113, v68, v76
    v_cvt_pk_bf16_f32 v114, v84, v92
    v_cvt_pk_bf16_f32 v115, v100, v108
    buffer_store_dwordx4 v[112:115], v2, s[40:43], 0 offen
    v_add_u32 v2, 4224, v2
    v_cvt_pk_bf16_f32 v116, v53, v61
    v_cvt_pk_bf16_f32 v117, v69, v77
    v_cvt_pk_bf16_f32 v118, v85, v93
    v_cvt_pk_bf16_f32 v119, v101, v109
    buffer_store_dwordx4 v[116:119], v2, s[40:43], 0 offen
    v_add_u32 v2, 4224, v2
    v_cvt_pk_bf16_f32 v120, v54, v62
    v_cvt_pk_bf16_f32 v121, v70, v78
    v_cvt_pk_bf16_f32 v122, v86, v94
    v_cvt_pk_bf16_f32 v123, v102, v110
    buffer_store_dwordx4 v[120:123], v2, s[40:43], 0 offen
    v_add_u32 v2, 4224, v2
    v_cvt_pk_bf16_f32 v124, v55, v63
    v_cvt_pk_bf16_f32 v125, v71, v79
    v_cvt_pk_bf16_f32 v126, v87, v95
    v_cvt_pk_bf16_f32 v127, v103, v111
    buffer_store_dwordx4 v[124:127], v2, s[40:43], 0 offen
    v_add_u32 v2, 4224, v2
    s_endpgm
K1_TR:
    s_sub_u32 s4, s2, 576
    s_cmp_lt_u32 s4, 56
    s_cbranch_scc0 K1_TR2
    s_mov_b32 s36, s28
    s_and_b32 s37, s29, 0xffff
    s_mov_b32 s38, 1835008
    s_mov_b32 s39, 0x00020000
    s_add_u32 s40, s32, 6815744
    s_addc_u32 s41, s33, 0
    s_and_b32 s41, s41, 0xffff
    s_mov_b32 s42, 1835008
    s_mov_b32 s43, 0x00020000
    s_lshl_b32 s4, s4, 2
    s_add_u32 s4, s4, s3
    s_mul_i32 s5, s4, 2341
    s_lshr_b32 s5, s5, 16
    s_mul_i32 s6, s5, 28
    s_sub_u32 s6, s4, s6
    s_mov_b32 s7, 3584
    s_mov_b32 s34, 1024
    s_branch K1_TRGO
K1_TR2:
    s_mov_b32 s36, s30
    s_and_b32 s37, s31, 0xffff
    s_mov_b32 s38, 1835008
    s_mov_b32 s39, 0x00020000
    s_add_u32 s40, s32, 8912896
    s_addc_u32 s41, s33, 0
    s_and_b32 s41, s41, 0xffff
    s_mov_b32 s42, 1835008
    s_mov_b32 s43, 0x00020000
    s_sub_u32 s4, s4, 56
    s_lshl_b32 s4, s4, 2
    s_add_u32 s4, s4, s3
    s_lshr_b32 s5, s4, 3
    s_and_b32 s6, s4, 7
    s_mov_b32 s7, 1024
    s_mov_b32 s34, 3584
K1_TRGO:
    v_and_b32 v2, 7, v1
    v_lshrrev_b32 v3, 3, v1
    s_lshl_b32 s5, s5, 6
    s_lshl_b32 s6, s6, 6
    v_lshlrev_b32 v4, 3, v3
    v_add_u32 v4, s5, v4
    v_lshlrev_b32 v5, 3, v2
    v_add_u32 v5, s6, v5
    v_mul_lo_u32 v6, v4, s7
    v_lshl_add_u32 v6, v5, 1, v6
    v_mul_lo_u32 v7, v5, s34
    v_lshl_add_u32 v7, v4, 1, v7
    buffer_load_dwordx4 v[16:19], v6, s[36:39], 0 offen
    v_add_u32 v6, s7, v6
    buffer_load_dwordx4 v[20:23], v6, s[36:39], 0 offen
    v_add_u32 v6, s7, v6
    buffer_load_dwordx4 v[24:27], v6, s[36:39], 0 offen
    v_add_u32 v6, s7, v6
    buffer_load_dwordx4 v[28:31], v6, s[36:39], 0 offen
    v_add_u32 v6, s7, v6
    buffer_load_dwordx4 v[32:35], v6, s[36:39], 0 offen
    v_add_u32 v6, s7, v6
    buffer_load_dwordx4 v[36:39], v6, s[36:39], 0 offen
    v_add_u32 v6, s7, v6
    buffer_load_dwordx4 v[40:43], v6, s[36:39], 0 offen
    v_add_u32 v6, s7, v6
    buffer_load_dwordx4 v[44:47], v6, s[36:39], 0 offen
    v_add_u32 v6, s7, v6
    s_mov_b32 s8, 0x05040100
    s_mov_b32 s9, 0x07060302
    s_waitcnt vmcnt(0)
    v_perm_b32 v64, v20, v16, s8
    v_perm_b32 v65, v28, v24, s8
    v_perm_b32 v66, v36, v32, s8
    v_perm_b32 v67, v44, v40, s8
    buffer_store_dwordx4 v[64:67], v7, s[40:43], 0 offen
    v_add_u32 v7, s34, v7
    s_nop 1
    v_perm_b32 v68, v20, v16, s9
    v_perm_b32 v69, v28, v24, s9
    v_perm_b32 v70, v36, v32, s9
    v_perm_b32 v71, v44, v40, s9
    buffer_store_dwordx4 v[68:71], v7, s[40:43], 0 offen
    v_add_u32 v7, s34, v7
    s_nop 1
    v_perm_b32 v64, v21, v17, s8
    v_perm_b32 v65, v29, v25, s8
    v_perm_b32 v66, v37, v33, s8
    v_perm_b32 v67, v45, v41, s8
    buffer_store_dwordx4 v[64:67], v7, s[40:43], 0 offen
    v_add_u32 v7, s34, v7
    s_nop 1
    v_perm_b32 v68, v21, v17, s9
    v_perm_b32 v69, v29, v25, s9
    v_perm_b32 v70, v37, v33, s9
    v_perm_b32 v71, v45, v41, s9
    buffer_store_dwordx4 v[68:71], v7, s[40:43], 0 offen
    v_add_u32 v7, s34, v7
    s_nop 1
    v_perm_b32 v64, v22, v18, s8
    v_perm_b32 v65, v30, v26, s8
    v_perm_b32 v66, v38, v34, s8
    v_perm_b32 v67, v46, v42, s8
    buffer_store_dwordx4 v[64:67], v7, s[40:43], 0 offen
    v_add_u32 v7, s34, v7
    s_nop 1
    v_perm_b32 v68, v22, v18, s9
    v_perm_b32 v69, v30, v26, s9
    v_perm_b32 v70, v38, v34, s9
    v_perm_b32 v71, v46, v42, s9
    buffer_store_dwordx4 v[68:71], v7, s[40:43], 0 offen
    v_add_u32 v7, s34, v7
    s_nop 1
    v_perm_b32 v64, v23, v19, s8
    v_perm_b32 v65, v31, v27, s8
    v_perm_b32 v66, v39, v35, s8
    v_perm_b32 v67, v47, v43, s8
    buffer_store_dwordx4 v[64:67], v7, s[40:43], 0 offen
    v_add_u32 v7, s34, v7
    s_nop 1
    v_perm_b32 v68, v23, v19, s9
    v_perm_b32 v69, v31, v27, s9
    v_perm_b32 v70, v39, v35, s9
    v_perm_b32 v71, v47, v43, s9
    buffer_store_dwordx4 v[68:71], v7, s[40:43], 0 offen
    v_add_u32 v7, s34, v7
    s_nop 1
    s_endpgm
.globl k2_conv_kernel
.p2align 8
.type k2_conv_kernel,@function
k2_conv_kernel:
    s_cmp_ge_u32 s2, 512
    s_cbranch_scc1 K2_END
    s_load_dwordx2 s[8:9], s[0:1], 64
    s_load_dwordx2 s[32:33], s[0:1], 112
    v_lshrrev_b32 v1, 6, v0
    s_nop 1
    v_readfirstlane_b32 s3, v1
    v_and_b32 v1, 63, v0
    s_waitcnt lgkmcnt(0)
    s_add_u32 s36, s32, 20971520
    s_addc_u32 s37, s33, 0
    s_and_b32 s37, s37, 0xffff
    s_mov_b32 s38, 8388608
    s_mov_b32 s39, 0x00020000
    s_add_u32 s40, s32, 0
    s_addc_u32 s41, s33, 0
    s_and_b32 s41, s41, 0xffff
    s_mov_b32 s42, 2162688
    s_mov_b32 s43, 0x00020000
    s_add_u32 s44, s32, 2359296
    s_addc_u32 s45, s33, 0
    s_and_b32 s45, s45, 0xffff
    s_mov_b32 s46, 2162688
    s_mov_b32 s47, 0x00020000
    s_add_u32 s48, s32, 11010048
    s_addc_u32 s49, s33, 0
    s_and_b32 s49, s49, 0xffff
    s_mov_b32 s50, 2162688
    s_mov_b32 s51, 0x00020000
    s_mov_b32 s52, s8
    s_and_b32 s53, s9, 0xffff
    s_mov_b32 s54, 1024
    s_mov_b32 s55, 0x00020000
    s_lshl_b32 s4, s2, 14
    s_movk_i32 s16, 0x1000
    s_movk_i32 s17, 0x2000
    s_movk_i32 s18, 0x3000
    s_mul_i32 s10, s2, 4224
    v_lshlrev_b32 v2, 4, v0
    v_add_u32 v3, s10, v2
    buffer_load_dwordx4 v[8:11], v3, s[40:43], 0 offen
    s_lshl_b32 s5, s2, 1
    v_mov_b32 v4, s5
    buffer_load_ushort v6, v4, s[52:55], 0 offen
    v_mov_b32 v12, 0
    v_mov_b32 v13, 0
    v_mov_b32 v14, 0
    v_mov_b32 v15, 0
    v_cmp_gt_u32 vcc, 32, v0
    s_and_saveexec_b64 s[6:7], vcc
    v_add_u32 v7, 66624, v2
    ds_write_b128 v7, v[12:15]
    s_mov_b64 exec, s[6:7]
    v_add_u32 v5, 1, v0
    v_lshlrev_b32 v16, 3, v5
    v_sub_u32 v16, 2055, v16
    v_subrev_u32 v17, 0, v16
    v_cvt_f32_i32 v18, v17
    v_cvt_pk_bf16_f32 v18, v18, v18
    v_and_b32 v18, 0xffff, v18
    v_subrev_u32 v18, 17024, v18
    v_cmp_gt_u32 vcc, 128, v17
    s_nop 1
    v_cndmask_b32 v18, v18, v17, vcc
    v_lshlrev_b32 v18, 2, v18
    v_add_u32 v18, s4, v18
    v_cmp_gt_u32 vcc, 2048, v17
    v_mov_b32 v19, 0x7ffffff0
    s_nop 0
    v_cndmask_b32 v18, v19, v18, vcc
    buffer_load_dword v32, v18, s[36:39], 0 offen

    v_subrev_u32 v17, 1, v16
    v_cvt_f32_i32 v18, v17
    v_cvt_pk_bf16_f32 v18, v18, v18
    v_and_b32 v18, 0xffff, v18
    v_subrev_u32 v18, 17024, v18
    v_cmp_gt_u32 vcc, 128, v17
    s_nop 1
    v_cndmask_b32 v18, v18, v17, vcc
    v_lshlrev_b32 v18, 2, v18
    v_add_u32 v18, s4, v18
    v_cmp_gt_u32 vcc, 2048, v17
    v_mov_b32 v19, 0x7ffffff0
    s_nop 0
    v_cndmask_b32 v18, v19, v18, vcc
    buffer_load_dword v33, v18, s[36:39], 0 offen

    v_subrev_u32 v17, 2, v16
    v_cvt_f32_i32 v18, v17
    v_cvt_pk_bf16_f32 v18, v18, v18
    v_and_b32 v18, 0xffff, v18
    v_subrev_u32 v18, 17024, v18
    v_cmp_gt_u32 vcc, 128, v17
    s_nop 1
    v_cndmask_b32 v18, v18, v17, vcc
    v_lshlrev_b32 v18, 2, v18
    v_add_u32 v18, s4, v18
    v_cmp_gt_u32 vcc, 2048, v17
    v_mov_b32 v19, 0x7ffffff0
    s_nop 0
    v_cndmask_b32 v18, v19, v18, vcc
    buffer_load_dword v34, v18, s[36:39], 0 offen

    v_subrev_u32 v17, 3, v16
    v_cvt_f32_i32 v18, v17
    v_cvt_pk_bf16_f32 v18, v18, v18
    v_and_b32 v18, 0xffff, v18
    v_subrev_u32 v18, 17024, v18
    v_cmp_gt_u32 vcc, 128, v17
    s_nop 1
    v_cndmask_b32 v18, v18, v17, vcc
    v_lshlrev_b32 v18, 2, v18
    v_add_u32 v18, s4, v18
    v_cmp_gt_u32 vcc, 2048, v17
    v_mov_b32 v19, 0x7ffffff0
    s_nop 0
    v_cndmask_b32 v18, v19, v18, vcc
    buffer_load_dword v35, v18, s[36:39], 0 offen

    v_subrev_u32 v17, 4, v16
    v_cvt_f32_i32 v18, v17
    v_cvt_pk_bf16_f32 v18, v18, v18
    v_and_b32 v18, 0xffff, v18
    v_subrev_u32 v18, 17024, v18
    v_cmp_gt_u32 vcc, 128, v17
    s_nop 1
    v_cndmask_b32 v18, v18, v17, vcc
    v_lshlrev_b32 v18, 2, v18
    v_add_u32 v18, s4, v18
    v_cmp_gt_u32 vcc, 2048, v17
    v_mov_b32 v19, 0x7ffffff0
    s_nop 0
    v_cndmask_b32 v18, v19, v18, vcc
    buffer_load_dword v36, v18, s[36:39], 0 offen

    v_subrev_u32 v17, 5, v16
    v_cvt_f32_i32 v18, v17
    v_cvt_pk_bf16_f32 v18, v18, v18
    v_and_b32 v18, 0xffff, v18
    v_subrev_u32 v18, 17024, v18
    v_cmp_gt_u32 vcc, 128, v17
    s_nop 1
    v_cndmask_b32 v18, v18, v17, vcc
    v_lshlrev_b32 v18, 2, v18
    v_add_u32 v18, s4, v18
    v_cmp_gt_u32 vcc, 2048, v17
    v_mov_b32 v19, 0x7ffffff0
    s_nop 0
    v_cndmask_b32 v18, v19, v18, vcc
    buffer_load_dword v37, v18, s[36:39], 0 offen

    v_subrev_u32 v17, 6, v16
    v_cvt_f32_i32 v18, v17
    v_cvt_pk_bf16_f32 v18, v18, v18
    v_and_b32 v18, 0xffff, v18
    v_subrev_u32 v18, 17024, v18
    v_cmp_gt_u32 vcc, 128, v17
    s_nop 1
    v_cndmask_b32 v18, v18, v17, vcc
    v_lshlrev_b32 v18, 2, v18
    v_add_u32 v18, s4, v18
    v_cmp_gt_u32 vcc, 2048, v17
    v_mov_b32 v19, 0x7ffffff0
    s_nop 0
    v_cndmask_b32 v18, v19, v18, vcc
    buffer_load_dword v38, v18, s[36:39], 0 offen

    v_subrev_u32 v17, 7, v16
    v_cvt_f32_i32 v18, v17
    v_cvt_pk_bf16_f32 v18, v18, v18
    v_and_b32 v18, 0xffff, v18
    v_subrev_u32 v18, 17024, v18
    v_cmp_gt_u32 vcc, 128, v17
    s_nop 1
    v_cndmask_b32 v18, v18, v17, vcc
    v_lshlrev_b32 v18, 2, v18
    v_add_u32 v18, s4, v18
    v_cmp_gt_u32 vcc, 2048, v17
    v_mov_b32 v19, 0x7ffffff0
    s_nop 0
    v_cndmask_b32 v18, v19, v18, vcc
    buffer_load_dword v39, v18, s[36:39], 0 offen

    v_subrev_u32 v17, 8, v16
    v_cvt_f32_i32 v18, v17
    v_cvt_pk_bf16_f32 v18, v18, v18
    v_and_b32 v18, 0xffff, v18
    v_subrev_u32 v18, 17024, v18
    v_cmp_gt_u32 vcc, 128, v17
    s_nop 1
    v_cndmask_b32 v18, v18, v17, vcc
    v_lshlrev_b32 v18, 2, v18
    v_add_u32 v18, s4, v18
    v_cmp_gt_u32 vcc, 2048, v17
    v_mov_b32 v19, 0x7ffffff0
    s_nop 0
    v_cndmask_b32 v18, v19, v18, vcc
    buffer_load_dword v40, v18, s[36:39], 0 offen

    v_subrev_u32 v17, 9, v16
    v_cvt_f32_i32 v18, v17
    v_cvt_pk_bf16_f32 v18, v18, v18
    v_and_b32 v18, 0xffff, v18
    v_subrev_u32 v18, 17024, v18
    v_cmp_gt_u32 vcc, 128, v17
    s_nop 1
    v_cndmask_b32 v18, v18, v17, vcc
    v_lshlrev_b32 v18, 2, v18
    v_add_u32 v18, s4, v18
    v_cmp_gt_u32 vcc, 2048, v17
    v_mov_b32 v19, 0x7ffffff0
    s_nop 0
    v_cndmask_b32 v18, v19, v18, vcc
    buffer_load_dword v41, v18, s[36:39], 0 offen

    v_subrev_u32 v17, 10, v16
    v_cvt_f32_i32 v18, v17
    v_cvt_pk_bf16_f32 v18, v18, v18
    v_and_b32 v18, 0xffff, v18
    v_subrev_u32 v18, 17024, v18
    v_cmp_gt_u32 vcc, 128, v17
    s_nop 1
    v_cndmask_b32 v18, v18, v17, vcc
    v_lshlrev_b32 v18, 2, v18
    v_add_u32 v18, s4, v18
    v_cmp_gt_u32 vcc, 2048, v17
    v_mov_b32 v19, 0x7ffffff0
    s_nop 0
    v_cndmask_b32 v18, v19, v18, vcc
    buffer_load_dword v42, v18, s[36:39], 0 offen

    v_subrev_u32 v17, 11, v16
    v_cvt_f32_i32 v18, v17
    v_cvt_pk_bf16_f32 v18, v18, v18
    v_and_b32 v18, 0xffff, v18
    v_subrev_u32 v18, 17024, v18
    v_cmp_gt_u32 vcc, 128, v17
    s_nop 1
    v_cndmask_b32 v18, v18, v17, vcc
    v_lshlrev_b32 v18, 2, v18
    v_add_u32 v18, s4, v18
    v_cmp_gt_u32 vcc, 2048, v17
    v_mov_b32 v19, 0x7ffffff0
    s_nop 0
    v_cndmask_b32 v18, v19, v18, vcc
    buffer_load_dword v43, v18, s[36:39], 0 offen

    v_subrev_u32 v17, 12, v16
    v_cvt_f32_i32 v18, v17
    v_cvt_pk_bf16_f32 v18, v18, v18
    v_and_b32 v18, 0xffff, v18
    v_subrev_u32 v18, 17024, v18
    v_cmp_gt_u32 vcc, 128, v17
    s_nop 1
    v_cndmask_b32 v18, v18, v17, vcc
    v_lshlrev_b32 v18, 2, v18
    v_add_u32 v18, s4, v18
    v_cmp_gt_u32 vcc, 2048, v17
    v_mov_b32 v19, 0x7ffffff0
    s_nop 0
    v_cndmask_b32 v18, v19, v18, vcc
    buffer_load_dword v44, v18, s[36:39], 0 offen

    v_subrev_u32 v17, 13, v16
    v_cvt_f32_i32 v18, v17
    v_cvt_pk_bf16_f32 v18, v18, v18
    v_and_b32 v18, 0xffff, v18
    v_subrev_u32 v18, 17024, v18
    v_cmp_gt_u32 vcc, 128, v17
    s_nop 1
    v_cndmask_b32 v18, v18, v17, vcc
    v_lshlrev_b32 v18, 2, v18
    v_add_u32 v18, s4, v18
    v_cmp_gt_u32 vcc, 2048, v17
    v_mov_b32 v19, 0x7ffffff0
    s_nop 0
    v_cndmask_b32 v18, v19, v18, vcc
    buffer_load_dword v45, v18, s[36:39], 0 offen

    v_subrev_u32 v17, 14, v16
    v_cvt_f32_i32 v18, v17
    v_cvt_pk_bf16_f32 v18, v18, v18
    v_and_b32 v18, 0xffff, v18
    v_subrev_u32 v18, 17024, v18
    v_cmp_gt_u32 vcc, 128, v17
    s_nop 1
    v_cndmask_b32 v18, v18, v17, vcc
    v_lshlrev_b32 v18, 2, v18
    v_add_u32 v18, s4, v18
    v_cmp_gt_u32 vcc, 2048, v17
    v_mov_b32 v19, 0x7ffffff0
    s_nop 0
    v_cndmask_b32 v18, v19, v18, vcc
    buffer_load_dword v46, v18, s[36:39], 0 offen

    v_mov_b32 v47, 0
    s_waitcnt vmcnt(0)
    v_cvt_pk_bf16_f32 v48, v32, v33
    v_cvt_pk_bf16_f32 v49, v34, v35
    v_cvt_pk_bf16_f32 v50, v36, v37
    v_cvt_pk_bf16_f32 v51, v38, v39
    v_cvt_pk_bf16_f32 v52, v40, v41
    v_cvt_pk_bf16_f32 v53, v42, v43
    v_cvt_pk_bf16_f32 v54, v44, v45
    v_cvt_pk_bf16_f32 v55, v46, v47
    v_lshlrev_b32 v20, 16, v48
    v_and_b32 v21, 0xffff0000, v48
    v_sub_f32 v20, v32, v20
    v_sub_f32 v21, v33, v21
    v_cvt_pk_bf16_f32 v56, v20, v21
    v_lshlrev_b32 v20, 16, v49
    v_and_b32 v21, 0xffff0000, v49
    v_sub_f32 v20, v34, v20
    v_sub_f32 v21, v35, v21
    v_cvt_pk_bf16_f32 v57, v20, v21
    v_lshlrev_b32 v20, 16, v50
    v_and_b32 v21, 0xffff0000, v50
    v_sub_f32 v20, v36, v20
    v_sub_f32 v21, v37, v21
    v_cvt_pk_bf16_f32 v58, v20, v21
    v_lshlrev_b32 v20, 16, v51
    v_and_b32 v21, 0xffff0000, v51
    v_sub_f32 v20, v38, v20
    v_sub_f32 v21, v39, v21
    v_cvt_pk_bf16_f32 v59, v20, v21
    v_lshlrev_b32 v20, 16, v52
    v_and_b32 v21, 0xffff0000, v52
    v_sub_f32 v20, v40, v20
    v_sub_f32 v21, v41, v21
    v_cvt_pk_bf16_f32 v60, v20, v21
    v_lshlrev_b32 v20, 16, v53
    v_and_b32 v21, 0xffff0000, v53
    v_sub_f32 v20, v42, v20
    v_sub_f32 v21, v43, v21
    v_cvt_pk_bf16_f32 v61, v20, v21
    v_lshlrev_b32 v20, 16, v54
    v_and_b32 v21, 0xffff0000, v54
    v_sub_f32 v20, v44, v20
    v_sub_f32 v21, v45, v21
    v_cvt_pk_bf16_f32 v62, v20, v21
    v_lshlrev_b32 v20, 16, v55
    v_and_b32 v21, 0xffff0000, v55
    v_sub_f32 v20, v46, v20
    v_sub_f32 v21, v47, v21
    v_cvt_pk_bf16_f32 v63, v20, v21
    v_lshlrev_b32 v22, 4, v5
    v_alignbit_b32 v28, v52, v51, 16
    v_alignbit_b32 v29, v53, v52, 16
    v_alignbit_b32 v30, v54, v53, 16
    v_alignbit_b32 v31, v55, v54, 16
    ds_write_b128 v22, v[28:31] offset:64
    v_mov_b32 v24, v51
    v_mov_b32 v25, v52
    v_mov_b32 v26, v53
    v_mov_b32 v27, v54
    ds_write_b128 v22, v[24:27] offset:4224
    v_alignbit_b32 v28, v51, v50, 16
    v_alignbit_b32 v29, v52, v51, 16
    v_alignbit_b32 v30, v53, v52, 16
    v_alignbit_b32 v31, v54, v53, 16
    ds_write_b128 v22, v[28:31] offset:8384
    ds_write_b128 v22, v[50:53] offset:12544
    v_alignbit_b32 v28, v50, v49, 16
    v_alignbit_b32 v29, v51, v50, 16
    v_alignbit_b32 v30, v52, v51, 16
    v_alignbit_b32 v31, v53, v52, 16
    ds_write_b128 v22, v[28:31] offset:16704
    v_mov_b32 v24, v49
    v_mov_b32 v25, v50
    v_mov_b32 v26, v51
    v_mov_b32 v27, v52
    ds_write_b128 v22, v[24:27] offset:20864
    v_alignbit_b32 v28, v49, v48, 16
    v_alignbit_b32 v29, v50, v49, 16
    v_alignbit_b32 v30, v51, v50, 16
    v_alignbit_b32 v31, v52, v51, 16
    ds_write_b128 v22, v[28:31] offset:25024
    ds_write_b128 v22, v[48:51] offset:29184
    v_alignbit_b32 v28, v60, v59, 16
    v_alignbit_b32 v29, v61, v60, 16
    v_alignbit_b32 v30, v62, v61, 16
    v_alignbit_b32 v31, v63, v62, 16
    ds_write_b128 v22, v[28:31] offset:33344
    v_mov_b32 v24, v59
    v_mov_b32 v25, v60
    v_mov_b32 v26, v61
    v_mov_b32 v27, v62
    ds_write_b128 v22, v[24:27] offset:37504
    v_alignbit_b32 v28, v59, v58, 16
    v_alignbit_b32 v29, v60, v59, 16
    v_alignbit_b32 v30, v61, v60, 16
    v_alignbit_b32 v31, v62, v61, 16
    ds_write_b128 v22, v[28:31] offset:41664
    ds_write_b128 v22, v[58:61] offset:45824
    v_alignbit_b32 v28, v58, v57, 16
    v_alignbit_b32 v29, v59, v58, 16
    v_alignbit_b32 v30, v60, v59, 16
    v_alignbit_b32 v31, v61, v60, 16
    ds_write_b128 v22, v[28:31] offset:49984
    v_mov_b32 v24, v57
    v_mov_b32 v25, v58
    v_mov_b32 v26, v59
    v_mov_b32 v27, v60
    ds_write_b128 v22, v[24:27] offset:54144
    v_alignbit_b32 v28, v57, v56, 16
    v_alignbit_b32 v29, v58, v57, 16
    v_alignbit_b32 v30, v59, v58, 16
    v_alignbit_b32 v31, v60, v59, 16
    ds_write_b128 v22, v[28:31] offset:58304
    ds_write_b128 v22, v[56:59] offset:62464
    v_mul_u32_u24 v16, 0x5556, v0
    v_lshrrev_b32 v16, 16, v16
    v_mul_u32_u24 v17, 3, v16
    v_sub_u32 v17, v0, v17
    s_mov_b32 s11, 4160
    v_mul_lo_u32 v16, v16, s11
    v_lshl_add_u32 v16, v17, 4, v16
    v_cmp_gt_u32 vcc, 48, v0
    s_and_saveexec_b64 s[6:7], vcc
    ds_write_b128 v16, v[12:15] offset:4176
    s_mov_b64 exec, s[6:7]
    v_add_u32 v7, 66624, v2
    ds_write_b128 v7, v[8:11] offset:512
    s_waitcnt lgkmcnt(0)
    s_barrier
    v_and_b32 v2, 15, v1
    v_lshrrev_b32 v3, 4, v1
    v_and_b32 v4, 7, v1
    s_mov_b32 s6, 4160
    v_mul_lo_u32 v5, v4, s6
    v_lshrrev_b32 v7, 3, v2
    v_sub_u32 v7, v3, v7
    v_lshlrev_b32 v7, 4, v7
    v_add_u32 v5, v5, v7
    v_add_u32 v5, 4128, v5
    v_lshlrev_b32 v7, 5, v2
    v_lshl_add_u32 v7, v3, 4, v7
    v_add_u32 v7, 67104, v7
    s_lshl_b32 s6, s3, 9
    v_add_u32 v8, s6, v7
    s_sub_u32 s7, 7, s3
    s_lshl_b32 s7, s7, 9
    v_add_u32 v9, s7, v7
    v_mov_b32 v16, 0
    v_mov_b32 v17, 0
    v_mov_b32 v18, 0
    v_mov_b32 v19, 0
    v_mov_b32 v20, 0
    v_mov_b32 v21, 0
    v_mov_b32 v22, 0
    v_mov_b32 v23, 0
    ds_read_b128 v[32:35], v5
    ds_read_b128 v[36:39], v5 offset:33280
    ds_read_b128 v[40:43], v9
    ds_read_b128 v[44:47], v8
    s_lshl_b32 s8, s3, 2
    s_add_u32 s8, s8, 4
K2_L1:
    v_subrev_u32 v5, 64, v5
    v_subrev_u32 v8, 64, v8
    v_subrev_u32 v9, 64, v9
    ds_read_b128 v[48:51], v5
    ds_read_b128 v[52:55], v5 offset:33280
    ds_read_b128 v[56:59], v9
    ds_read_b128 v[60:63], v8
    s_waitcnt lgkmcnt(4)
    v_mfma_f32_16x16x32_bf16 v[20:23], v[32:35], v[40:43], v[20:23]
    v_mfma_f32_16x16x32_bf16 v[16:19], v[32:35], v[44:47], v[16:19]
    v_mfma_f32_16x16x32_bf16 v[20:23], v[36:39], v[40:43], v[20:23]
    v_mfma_f32_16x16x32_bf16 v[16:19], v[36:39], v[44:47], v[16:19]
    v_subrev_u32 v5, 64, v5
    v_subrev_u32 v8, 64, v8
    v_subrev_u32 v9, 64, v9
    ds_read_b128 v[32:35], v5
    ds_read_b128 v[36:39], v5 offset:33280
    ds_read_b128 v[40:43], v9
    ds_read_b128 v[44:47], v8
    s_waitcnt lgkmcnt(4)
    v_mfma_f32_16x16x32_bf16 v[20:23], v[48:51], v[56:59], v[20:23]
    v_mfma_f32_16x16x32_bf16 v[16:19], v[48:51], v[60:63], v[16:19]
    v_mfma_f32_16x16x32_bf16 v[20:23], v[52:55], v[56:59], v[20:23]
    v_mfma_f32_16x16x32_bf16 v[16:19], v[52:55], v[60:63], v[16:19]
    s_sub_u32 s8, s8, 1
    s_cmp_lg_u32 s8, 0
    s_cbranch_scc1 K2_L1
    s_lshl_b32 s8, s3, 3
    s_sub_u32 s8, 28, s8
K2_L2:
    v_subrev_u32 v5, 64, v5
    v_subrev_u32 v8, 64, v8
    v_subrev_u32 v9, 64, v9
    ds_read_b128 v[48:51], v5
    ds_read_b128 v[52:55], v5 offset:33280
    ds_read_b128 v[56:59], v9
    s_waitcnt lgkmcnt(3)
    v_mfma_f32_16x16x32_bf16 v[20:23], v[32:35], v[40:43], v[20:23]
    v_mfma_f32_16x16x32_bf16 v[20:23], v[36:39], v[40:43], v[20:23]
    v_subrev_u32 v5, 64, v5
    v_subrev_u32 v8, 64, v8
    v_subrev_u32 v9, 64, v9
    ds_read_b128 v[32:35], v5
    ds_read_b128 v[36:39], v5 offset:33280
    ds_read_b128 v[40:43], v9
    s_waitcnt lgkmcnt(3)
    v_mfma_f32_16x16x32_bf16 v[20:23], v[48:51], v[56:59], v[20:23]
    v_mfma_f32_16x16x32_bf16 v[20:23], v[52:55], v[56:59], v[20:23]
    s_sub_u32 s8, s8, 1
    s_cmp_lg_u32 s8, 0
    s_cbranch_scc1 K2_L2
    s_waitcnt lgkmcnt(0)
    v_lshlrev_b32 v7, 5, v2
    v_lshl_add_u32 v7, v3, 3, v7
    v_add_u32 v7, s10, v7
    v_add_u32 v8, s6, v7
    v_add_u32 v9, s7, v7
    buffer_load_dwordx2 v[32:33], v8, s[40:43], 0 offen
    buffer_load_dwordx2 v[34:35], v8, s[44:47], 0 offen
    buffer_load_dwordx2 v[36:37], v9, s[40:43], 0 offen
    buffer_load_dwordx2 v[38:39], v9, s[44:47], 0 offen
    v_lshlrev_b32 v6, 16, v6
    s_nop 7
    s_waitcnt vmcnt(0)
    v_lshlrev_b32 v40, 16, v32
    v_lshlrev_b32 v41, 16, v34
    v_mul_f32 v40, v40, v6
    v_cvt_pk_bf16_f32 v40, v40, v40
    v_and_b32 v40, 0xffff0000, v40
    v_cvt_pk_bf16_f32 v42, v16, v16
    v_and_b32 v42, 0xffff0000, v42
    v_add_f32 v40, v40, v42
    v_cvt_pk_bf16_f32 v40, v40, v40
    v_and_b32 v40, 0xffff0000, v40
    v_add_f32 v44, v40, v41

    v_and_b32 v40, 0xffff0000, v32
    v_and_b32 v41, 0xffff0000, v34
    v_mul_f32 v40, v40, v6
    v_cvt_pk_bf16_f32 v40, v40, v40
    v_and_b32 v40, 0xffff0000, v40
    v_cvt_pk_bf16_f32 v42, v17, v17
    v_and_b32 v42, 0xffff0000, v42
    v_add_f32 v40, v40, v42
    v_cvt_pk_bf16_f32 v40, v40, v40
    v_and_b32 v40, 0xffff0000, v40
    v_add_f32 v45, v40, v41

    v_lshlrev_b32 v40, 16, v33
    v_lshlrev_b32 v41, 16, v35
    v_mul_f32 v40, v40, v6
    v_cvt_pk_bf16_f32 v40, v40, v40
    v_and_b32 v40, 0xffff0000, v40
    v_cvt_pk_bf16_f32 v42, v18, v18
    v_and_b32 v42, 0xffff0000, v42
    v_add_f32 v40, v40, v42
    v_cvt_pk_bf16_f32 v40, v40, v40
    v_and_b32 v40, 0xffff0000, v40
    v_add_f32 v46, v40, v41

    v_and_b32 v40, 0xffff0000, v33
    v_and_b32 v41, 0xffff0000, v35
    v_mul_f32 v40, v40, v6
    v_cvt_pk_bf16_f32 v40, v40, v40
    v_and_b32 v40, 0xffff0000, v40
    v_cvt_pk_bf16_f32 v42, v19, v19
    v_and_b32 v42, 0xffff0000, v42
    v_add_f32 v40, v40, v42
    v_cvt_pk_bf16_f32 v40, v40, v40
    v_and_b32 v40, 0xffff0000, v40
    v_add_f32 v47, v40, v41

    v_cvt_pk_bf16_f32 v48, v44, v45
    v_cvt_pk_bf16_f32 v49, v46, v47
    buffer_store_dwordx2 v[48:49], v8, s[48:51], 0 offen
    s_nop 1
    v_lshlrev_b32 v40, 16, v36
    v_lshlrev_b32 v41, 16, v38
    v_mul_f32 v40, v40, v6
    v_cvt_pk_bf16_f32 v40, v40, v40
    v_and_b32 v40, 0xffff0000, v40
    v_cvt_pk_bf16_f32 v42, v20, v20
    v_and_b32 v42, 0xffff0000, v42
    v_add_f32 v40, v40, v42
    v_cvt_pk_bf16_f32 v40, v40, v40
    v_and_b32 v40, 0xffff0000, v40
    v_add_f32 v44, v40, v41

    v_and_b32 v40, 0xffff0000, v36
    v_and_b32 v41, 0xffff0000, v38
    v_mul_f32 v40, v40, v6
    v_cvt_pk_bf16_f32 v40, v40, v40
    v_and_b32 v40, 0xffff0000, v40
    v_cvt_pk_bf16_f32 v42, v21, v21
    v_and_b32 v42, 0xffff0000, v42
    v_add_f32 v40, v40, v42
    v_cvt_pk_bf16_f32 v40, v40, v40
    v_and_b32 v40, 0xffff0000, v40
    v_add_f32 v45, v40, v41

    v_lshlrev_b32 v40, 16, v37
    v_lshlrev_b32 v41, 16, v39
    v_mul_f32 v40, v40, v6
    v_cvt_pk_bf16_f32 v40, v40, v40
    v_and_b32 v40, 0xffff0000, v40
    v_cvt_pk_bf16_f32 v42, v22, v22
    v_and_b32 v42, 0xffff0000, v42
    v_add_f32 v40, v40, v42
    v_cvt_pk_bf16_f32 v40, v40, v40
    v_and_b32 v40, 0xffff0000, v40
    v_add_f32 v46, v40, v41

    v_and_b32 v40, 0xffff0000, v37
    v_and_b32 v41, 0xffff0000, v39
    v_mul_f32 v40, v40, v6
    v_cvt_pk_bf16_f32 v40, v40, v40
    v_and_b32 v40, 0xffff0000, v40
    v_cvt_pk_bf16_f32 v42, v23, v23
    v_and_b32 v42, 0xffff0000, v42
    v_add_f32 v40, v40, v42
    v_cvt_pk_bf16_f32 v40, v40, v40
    v_and_b32 v40, 0xffff0000, v40
    v_add_f32 v47, v40, v41

    v_cvt_pk_bf16_f32 v48, v44, v45
    v_cvt_pk_bf16_f32 v49, v46, v47
    buffer_store_dwordx2 v[48:49], v9, s[48:51], 0 offen
    s_nop 1
    s_waitcnt vmcnt(0)
K2_END:
    s_endpgm
.globl k3_ffn1_kernel
.p2align 8
.type k3_ffn1_kernel,@function
k3_ffn1_kernel:
    s_cmp_ge_u32 s2, 224
    s_cbranch_scc1 K3_END
    s_load_dwordx2 s[32:33], s[0:1], 112
    v_lshrrev_b32 v1, 6, v0
    s_nop 1
    v_readfirstlane_b32 s3, v1
    v_and_b32 v1, 63, v0
    s_lshr_b32 s6, s2, 3
    s_mul_i32 s4, s6, 9363
    s_lshr_b32 s4, s4, 16
    s_mul_i32 s5, s4, 7
    s_sub_u32 s5, s6, s5
    s_and_b32 s6, s2, 7
    s_lshl_b32 s6, s6, 2
    s_add_u32 s4, s4, s6
    s_waitcnt lgkmcnt(0)
    s_add_u32 s36, s32, 11010048
    s_addc_u32 s37, s33, 0
    s_and_b32 s37, s37, 0xffff
    s_mov_b32 s38, 2162688
    s_mov_b32 s39, 0x00020000
    s_add_u32 s40, s32, 6815744
    s_addc_u32 s41, s33, 0
    s_and_b32 s41, s41, 0xffff
    s_mov_b32 s42, 1835008
    s_mov_b32 s43, 0x00020000
    s_add_u32 s44, s32, 13369344
    s_addc_u32 s45, s33, 0
    s_and_b32 s45, s45, 0xffff
    s_mov_b32 s46, 7340032
    s_mov_b32 s47, 0x00020000
    v_and_b32 v2, 31, v1
    v_lshrrev_b32 v3, 5, v1
    s_lshl_b32 s6, s5, 8
    v_lshrrev_b32 v4, 3, v1
    v_and_b32 v5, 7, v1
    s_lshl_b32 s7, s3, 6
    s_add_u32 s7, s7, s6
    v_add_u32 v6, 0, v4
    v_lshrrev_b32 v7, 1, v6
    v_and_b32 v7, 7, v7
    v_xor_b32 v7, v7, v5
    v_add_u32 v6, s7, v6
    v_lshlrev_b32 v6, 10, v6
    v_lshl_add_u32 v32, v7, 4, v6
    v_add_u32 v6, 8, v4
    v_lshrrev_b32 v7, 1, v6
    v_and_b32 v7, 7, v7
    v_xor_b32 v7, v7, v5
    v_add_u32 v6, s7, v6
    v_lshlrev_b32 v6, 10, v6
    v_lshl_add_u32 v33, v7, 4, v6
    v_add_u32 v6, 16, v4
    v_lshrrev_b32 v7, 1, v6
    v_and_b32 v7, 7, v7
    v_xor_b32 v7, v7, v5
    v_add_u32 v6, s7, v6
    v_lshlrev_b32 v6, 10, v6
    v_lshl_add_u32 v34, v7, 4, v6
    v_add_u32 v6, 24, v4
    v_lshrrev_b32 v7, 1, v6
    v_and_b32 v7, 7, v7
    v_xor_b32 v7, v7, v5
    v_add_u32 v6, s7, v6
    v_lshlrev_b32 v6, 10, v6
    v_lshl_add_u32 v35, v7, 4, v6
    v_add_u32 v6, 32, v4
    v_lshrrev_b32 v7, 1, v6
    v_and_b32 v7, 7, v7
    v_xor_b32 v7, v7, v5
    v_add_u32 v6, s7, v6
    v_lshlrev_b32 v6, 10, v6
    v_lshl_add_u32 v36, v7, 4, v6
    v_add_u32 v6, 40, v4
    v_lshrrev_b32 v7, 1, v6
    v_and_b32 v7, 7, v7
    v_xor_b32 v7, v7, v5
    v_add_u32 v6, s7, v6
    v_lshlrev_b32 v6, 10, v6
    v_lshl_add_u32 v37, v7, 4, v6
    v_add_u32 v6, 48, v4
    v_lshrrev_b32 v7, 1, v6
    v_and_b32 v7, 7, v7
    v_xor_b32 v7, v7, v5
    v_add_u32 v6, s7, v6
    v_lshlrev_b32 v6, 10, v6
    v_lshl_add_u32 v38, v7, 4, v6
    v_add_u32 v6, 56, v4
    v_lshrrev_b32 v7, 1, v6
    v_and_b32 v7, 7, v7
    v_xor_b32 v7, v7, v5
    v_add_u32 v6, s7, v6
    v_lshlrev_b32 v6, 10, v6
    v_lshl_add_u32 v39, v7, 4, v6
    s_lshl_b32 s7, s3, 13
    s_add_u32 s7, s7, 0x10000
    s_mov_b32 s13, 0
    s_mov_b32 s16, 0
    s_add_u32 s12, s16, s7
    s_add_u32 m0, s12, 0
    s_nop 0
    buffer_load_dwordx4 v32, s[40:43], s13 offen lds
    s_add_u32 m0, s12, 1024
    s_nop 0
    buffer_load_dwordx4 v33, s[40:43], s13 offen lds
    s_add_u32 m0, s12, 2048
    s_nop 0
    buffer_load_dwordx4 v34, s[40:43], s13 offen lds
    s_add_u32 m0, s12, 3072
    s_nop 0
    buffer_load_dwordx4 v35, s[40:43], s13 offen lds
    s_add_u32 m0, s12, 4096
    s_nop 0
    buffer_load_dwordx4 v36, s[40:43], s13 offen lds
    s_add_u32 m0, s12, 5120
    s_nop 0
    buffer_load_dwordx4 v37, s[40:43], s13 offen lds
    s_add_u32 m0, s12, 6144
    s_nop 0
    buffer_load_dwordx4 v38, s[40:43], s13 offen lds
    s_add_u32 m0, s12, 7168
    s_nop 0
    buffer_load_dwordx4 v39, s[40:43], s13 offen lds
    s_add_u32 s13, s13, 128
    s_add_u32 s16, s16, 32768
    s_cmp_eq_u32 s16, 98304
    s_cselect_b32 s16, 0, s16
    s_add_u32 s12, s16, s7
    s_add_u32 m0, s12, 0
    s_nop 0
    buffer_load_dwordx4 v32, s[40:43], s13 offen lds
    s_add_u32 m0, s12, 1024
    s_nop 0
    buffer_load_dwordx4 v33, s[40:43], s13 offen lds
    s_add_u32 m0, s12, 2048
    s_nop 0
    buffer_load_dwordx4 v34, s[40:43], s13 offen lds
    s_add_u32 m0, s12, 3072
    s_nop 0
    buffer_load_dwordx4 v35, s[40:43], s13 offen lds
    s_add_u32 m0, s12, 4096
    s_nop 0
    buffer_load_dwordx4 v36, s[40:43], s13 offen lds
    s_add_u32 m0, s12, 5120
    s_nop 0
    buffer_load_dwordx4 v37, s[40:43], s13 offen lds
    s_add_u32 m0, s12, 6144
    s_nop 0
    buffer_load_dwordx4 v38, s[40:43], s13 offen lds
    s_add_u32 m0, s12, 7168
    s_nop 0
    buffer_load_dwordx4 v39, s[40:43], s13 offen lds
    s_add_u32 s13, s13, 128
    s_add_u32 s16, s16, 32768
    s_cmp_eq_u32 s16, 98304
    s_cselect_b32 s16, 0, s16
    v_and_b32 v6, 7, v0
    v_lshrrev_b32 v7, 3, v0
    s_mov_b32 s8, 8448
    v_mul_lo_u32 v8, v7, s8
    v_lshl_add_u32 v8, v6, 4, v8
    s_lshl_b32 s8, s4, 7
    v_add_u32 v8, s8, v8
    v_mov_b32 v14, v8
    s_mov_b32 s15, 4224
    buffer_load_dwordx4 v[128:131], v8, s[36:39], 0 offen
    buffer_load_dwordx4 v[132:135], v8, s[36:39], s15 offen
    v_add_u32 v8, 270336, v8
    buffer_load_dwordx4 v[136:139], v8, s[36:39], 0 offen
    buffer_load_dwordx4 v[140:143], v8, s[36:39], s15 offen
    v_add_u32 v8, 270336, v8
    buffer_load_dwordx4 v[144:147], v8, s[36:39], 0 offen
    buffer_load_dwordx4 v[148:151], v8, s[36:39], s15 offen
    v_add_u32 v8, 270336, v8
    buffer_load_dwordx4 v[152:155], v8, s[36:39], 0 offen
    buffer_load_dwordx4 v[156:159], v8, s[36:39], s15 offen
    v_add_u32 v8, 270336, v8
    buffer_load_dwordx4 v[160:163], v8, s[36:39], 0 offen
    buffer_load_dwordx4 v[164:167], v8, s[36:39], s15 offen
    v_add_u32 v8, 270336, v8
    buffer_load_dwordx4 v[168:171], v8, s[36:39], 0 offen
    buffer_load_dwordx4 v[172:175], v8, s[36:39], s15 offen
    v_add_u32 v8, 270336, v8
    buffer_load_dwordx4 v[176:179], v8, s[36:39], 0 offen
    buffer_load_dwordx4 v[180:183], v8, s[36:39], s15 offen
    v_add_u32 v8, 270336, v8
    buffer_load_dwordx4 v[184:187], v8, s[36:39], 0 offen
    buffer_load_dwordx4 v[188:191], v8, s[36:39], s15 offen
    v_add_u32 v8, 270336, v8
    v_mov_b32 v16, 0
    v_mov_b32 v17, 0
    v_mov_b32 v18, 0
    v_mov_b32 v19, 0
    v_mov_b32 v20, 0
    v_mov_b32 v21, 0
    v_mov_b32 v22, 0
    v_mov_b32 v23, 0
    v_mov_b32 v24, 0
    v_mov_b32 v25, 0
    v_mov_b32 v26, 0
    v_mov_b32 v27, 0
    v_mov_b32 v28, 0
    v_mov_b32 v29, 0
    v_mov_b32 v30, 0
    v_mov_b32 v31, 0
    s_waitcnt vmcnt(15)
    v_lshlrev_b32 v10, 16, v128
    v_add_f32 v16, v16, v10
    v_fma_f32 v24, v10, v10, v24
    v_and_b32 v11, 0xffff0000, v128
    v_add_f32 v17, v17, v11
    v_fma_f32 v25, v11, v11, v25
    v_lshlrev_b32 v10, 16, v129
    v_add_f32 v18, v18, v10
    v_fma_f32 v26, v10, v10, v26
    v_and_b32 v11, 0xffff0000, v129
    v_add_f32 v19, v19, v11
    v_fma_f32 v27, v11, v11, v27
    v_lshlrev_b32 v10, 16, v130
    v_add_f32 v20, v20, v10
    v_fma_f32 v28, v10, v10, v28
    v_and_b32 v11, 0xffff0000, v130
    v_add_f32 v21, v21, v11
    v_fma_f32 v29, v11, v11, v29
    v_lshlrev_b32 v10, 16, v131
    v_add_f32 v22, v22, v10
    v_fma_f32 v30, v10, v10, v30
    v_and_b32 v11, 0xffff0000, v131
    v_add_f32 v23, v23, v11
    v_fma_f32 v31, v11, v11, v31
    s_waitcnt vmcnt(14)
    v_lshlrev_b32 v10, 16, v132
    v_add_f32 v16, v16, v10
    v_fma_f32 v24, v10, v10, v24
    v_and_b32 v11, 0xffff0000, v132
    v_add_f32 v17, v17, v11
    v_fma_f32 v25, v11, v11, v25
    v_lshlrev_b32 v10, 16, v133
    v_add_f32 v18, v18, v10
    v_fma_f32 v26, v10, v10, v26
    v_and_b32 v11, 0xffff0000, v133
    v_add_f32 v19, v19, v11
    v_fma_f32 v27, v11, v11, v27
    v_lshlrev_b32 v10, 16, v134
    v_add_f32 v20, v20, v10
    v_fma_f32 v28, v10, v10, v28
    v_and_b32 v11, 0xffff0000, v134
    v_add_f32 v21, v21, v11
    v_fma_f32 v29, v11, v11, v29
    v_lshlrev_b32 v10, 16, v135
    v_add_f32 v22, v22, v10
    v_fma_f32 v30, v10, v10, v30
    v_and_b32 v11, 0xffff0000, v135
    v_add_f32 v23, v23, v11
    v_fma_f32 v31, v11, v11, v31
    s_waitcnt vmcnt(13)
    v_lshlrev_b32 v10, 16, v136
    v_add_f32 v16, v16, v10
    v_fma_f32 v24, v10, v10, v24
    v_and_b32 v11, 0xffff0000, v136
    v_add_f32 v17, v17, v11
    v_fma_f32 v25, v11, v11, v25
    v_lshlrev_b32 v10, 16, v137
    v_add_f32 v18, v18, v10
    v_fma_f32 v26, v10, v10, v26
    v_and_b32 v11, 0xffff0000, v137
    v_add_f32 v19, v19, v11
    v_fma_f32 v27, v11, v11, v27
    v_lshlrev_b32 v10, 16, v138
    v_add_f32 v20, v20, v10
    v_fma_f32 v28, v10, v10, v28
    v_and_b32 v11, 0xffff0000, v138
    v_add_f32 v21, v21, v11
    v_fma_f32 v29, v11, v11, v29
    v_lshlrev_b32 v10, 16, v139
    v_add_f32 v22, v22, v10
    v_fma_f32 v30, v10, v10, v30
    v_and_b32 v11, 0xffff0000, v139
    v_add_f32 v23, v23, v11
    v_fma_f32 v31, v11, v11, v31
    s_waitcnt vmcnt(12)
    v_lshlrev_b32 v10, 16, v140
    v_add_f32 v16, v16, v10
    v_fma_f32 v24, v10, v10, v24
    v_and_b32 v11, 0xffff0000, v140
    v_add_f32 v17, v17, v11
    v_fma_f32 v25, v11, v11, v25
    v_lshlrev_b32 v10, 16, v141
    v_add_f32 v18, v18, v10
    v_fma_f32 v26, v10, v10, v26
    v_and_b32 v11, 0xffff0000, v141
    v_add_f32 v19, v19, v11
    v_fma_f32 v27, v11, v11, v27
    v_lshlrev_b32 v10, 16, v142
    v_add_f32 v20, v20, v10
    v_fma_f32 v28, v10, v10, v28
    v_and_b32 v11, 0xffff0000, v142
    v_add_f32 v21, v21, v11
    v_fma_f32 v29, v11, v11, v29
    v_lshlrev_b32 v10, 16, v143
    v_add_f32 v22, v22, v10
    v_fma_f32 v30, v10, v10, v30
    v_and_b32 v11, 0xffff0000, v143
    v_add_f32 v23, v23, v11
    v_fma_f32 v31, v11, v11, v31
    s_waitcnt vmcnt(11)
    v_lshlrev_b32 v10, 16, v144
    v_add_f32 v16, v16, v10
    v_fma_f32 v24, v10, v10, v24
    v_and_b32 v11, 0xffff0000, v144
    v_add_f32 v17, v17, v11
    v_fma_f32 v25, v11, v11, v25
    v_lshlrev_b32 v10, 16, v145
    v_add_f32 v18, v18, v10
    v_fma_f32 v26, v10, v10, v26
    v_and_b32 v11, 0xffff0000, v145
    v_add_f32 v19, v19, v11
    v_fma_f32 v27, v11, v11, v27
    v_lshlrev_b32 v10, 16, v146
    v_add_f32 v20, v20, v10
    v_fma_f32 v28, v10, v10, v28
    v_and_b32 v11, 0xffff0000, v146
    v_add_f32 v21, v21, v11
    v_fma_f32 v29, v11, v11, v29
    v_lshlrev_b32 v10, 16, v147
    v_add_f32 v22, v22, v10
    v_fma_f32 v30, v10, v10, v30
    v_and_b32 v11, 0xffff0000, v147
    v_add_f32 v23, v23, v11
    v_fma_f32 v31, v11, v11, v31
    s_waitcnt vmcnt(10)
    v_lshlrev_b32 v10, 16, v148
    v_add_f32 v16, v16, v10
    v_fma_f32 v24, v10, v10, v24
    v_and_b32 v11, 0xffff0000, v148
    v_add_f32 v17, v17, v11
    v_fma_f32 v25, v11, v11, v25
    v_lshlrev_b32 v10, 16, v149
    v_add_f32 v18, v18, v10
    v_fma_f32 v26, v10, v10, v26
    v_and_b32 v11, 0xffff0000, v149
    v_add_f32 v19, v19, v11
    v_fma_f32 v27, v11, v11, v27
    v_lshlrev_b32 v10, 16, v150
    v_add_f32 v20, v20, v10
    v_fma_f32 v28, v10, v10, v28
    v_and_b32 v11, 0xffff0000, v150
    v_add_f32 v21, v21, v11
    v_fma_f32 v29, v11, v11, v29
    v_lshlrev_b32 v10, 16, v151
    v_add_f32 v22, v22, v10
    v_fma_f32 v30, v10, v10, v30
    v_and_b32 v11, 0xffff0000, v151
    v_add_f32 v23, v23, v11
    v_fma_f32 v31, v11, v11, v31
    s_waitcnt vmcnt(9)
    v_lshlrev_b32 v10, 16, v152
    v_add_f32 v16, v16, v10
    v_fma_f32 v24, v10, v10, v24
    v_and_b32 v11, 0xffff0000, v152
    v_add_f32 v17, v17, v11
    v_fma_f32 v25, v11, v11, v25
    v_lshlrev_b32 v10, 16, v153
    v_add_f32 v18, v18, v10
    v_fma_f32 v26, v10, v10, v26
    v_and_b32 v11, 0xffff0000, v153
    v_add_f32 v19, v19, v11
    v_fma_f32 v27, v11, v11, v27
    v_lshlrev_b32 v10, 16, v154
    v_add_f32 v20, v20, v10
    v_fma_f32 v28, v10, v10, v28
    v_and_b32 v11, 0xffff0000, v154
    v_add_f32 v21, v21, v11
    v_fma_f32 v29, v11, v11, v29
    v_lshlrev_b32 v10, 16, v155
    v_add_f32 v22, v22, v10
    v_fma_f32 v30, v10, v10, v30
    v_and_b32 v11, 0xffff0000, v155
    v_add_f32 v23, v23, v11
    v_fma_f32 v31, v11, v11, v31
    s_waitcnt vmcnt(8)
    v_lshlrev_b32 v10, 16, v156
    v_add_f32 v16, v16, v10
    v_fma_f32 v24, v10, v10, v24
    v_and_b32 v11, 0xffff0000, v156
    v_add_f32 v17, v17, v11
    v_fma_f32 v25, v11, v11, v25
    v_lshlrev_b32 v10, 16, v157
    v_add_f32 v18, v18, v10
    v_fma_f32 v26, v10, v10, v26
    v_and_b32 v11, 0xffff0000, v157
    v_add_f32 v19, v19, v11
    v_fma_f32 v27, v11, v11, v27
    v_lshlrev_b32 v10, 16, v158
    v_add_f32 v20, v20, v10
    v_fma_f32 v28, v10, v10, v28
    v_and_b32 v11, 0xffff0000, v158
    v_add_f32 v21, v21, v11
    v_fma_f32 v29, v11, v11, v29
    v_lshlrev_b32 v10, 16, v159
    v_add_f32 v22, v22, v10
    v_fma_f32 v30, v10, v10, v30
    v_and_b32 v11, 0xffff0000, v159
    v_add_f32 v23, v23, v11
    v_fma_f32 v31, v11, v11, v31
    s_waitcnt vmcnt(7)
    v_lshlrev_b32 v10, 16, v160
    v_add_f32 v16, v16, v10
    v_fma_f32 v24, v10, v10, v24
    v_and_b32 v11, 0xffff0000, v160
    v_add_f32 v17, v17, v11
    v_fma_f32 v25, v11, v11, v25
    v_lshlrev_b32 v10, 16, v161
    v_add_f32 v18, v18, v10
    v_fma_f32 v26, v10, v10, v26
    v_and_b32 v11, 0xffff0000, v161
    v_add_f32 v19, v19, v11
    v_fma_f32 v27, v11, v11, v27
    v_lshlrev_b32 v10, 16, v162
    v_add_f32 v20, v20, v10
    v_fma_f32 v28, v10, v10, v28
    v_and_b32 v11, 0xffff0000, v162
    v_add_f32 v21, v21, v11
    v_fma_f32 v29, v11, v11, v29
    v_lshlrev_b32 v10, 16, v163
    v_add_f32 v22, v22, v10
    v_fma_f32 v30, v10, v10, v30
    v_and_b32 v11, 0xffff0000, v163
    v_add_f32 v23, v23, v11
    v_fma_f32 v31, v11, v11, v31
    s_waitcnt vmcnt(6)
    v_lshlrev_b32 v10, 16, v164
    v_add_f32 v16, v16, v10
    v_fma_f32 v24, v10, v10, v24
    v_and_b32 v11, 0xffff0000, v164
    v_add_f32 v17, v17, v11
    v_fma_f32 v25, v11, v11, v25
    v_lshlrev_b32 v10, 16, v165
    v_add_f32 v18, v18, v10
    v_fma_f32 v26, v10, v10, v26
    v_and_b32 v11, 0xffff0000, v165
    v_add_f32 v19, v19, v11
    v_fma_f32 v27, v11, v11, v27
    v_lshlrev_b32 v10, 16, v166
    v_add_f32 v20, v20, v10
    v_fma_f32 v28, v10, v10, v28
    v_and_b32 v11, 0xffff0000, v166
    v_add_f32 v21, v21, v11
    v_fma_f32 v29, v11, v11, v29
    v_lshlrev_b32 v10, 16, v167
    v_add_f32 v22, v22, v10
    v_fma_f32 v30, v10, v10, v30
    v_and_b32 v11, 0xffff0000, v167
    v_add_f32 v23, v23, v11
    v_fma_f32 v31, v11, v11, v31
    s_waitcnt vmcnt(5)
    v_lshlrev_b32 v10, 16, v168
    v_add_f32 v16, v16, v10
    v_fma_f32 v24, v10, v10, v24
    v_and_b32 v11, 0xffff0000, v168
    v_add_f32 v17, v17, v11
    v_fma_f32 v25, v11, v11, v25
    v_lshlrev_b32 v10, 16, v169
    v_add_f32 v18, v18, v10
    v_fma_f32 v26, v10, v10, v26
    v_and_b32 v11, 0xffff0000, v169
    v_add_f32 v19, v19, v11
    v_fma_f32 v27, v11, v11, v27
    v_lshlrev_b32 v10, 16, v170
    v_add_f32 v20, v20, v10
    v_fma_f32 v28, v10, v10, v28
    v_and_b32 v11, 0xffff0000, v170
    v_add_f32 v21, v21, v11
    v_fma_f32 v29, v11, v11, v29
    v_lshlrev_b32 v10, 16, v171
    v_add_f32 v22, v22, v10
    v_fma_f32 v30, v10, v10, v30
    v_and_b32 v11, 0xffff0000, v171
    v_add_f32 v23, v23, v11
    v_fma_f32 v31, v11, v11, v31
    s_waitcnt vmcnt(4)
    v_lshlrev_b32 v10, 16, v172
    v_add_f32 v16, v16, v10
    v_fma_f32 v24, v10, v10, v24
    v_and_b32 v11, 0xffff0000, v172
    v_add_f32 v17, v17, v11
    v_fma_f32 v25, v11, v11, v25
    v_lshlrev_b32 v10, 16, v173
    v_add_f32 v18, v18, v10
    v_fma_f32 v26, v10, v10, v26
    v_and_b32 v11, 0xffff0000, v173
    v_add_f32 v19, v19, v11
    v_fma_f32 v27, v11, v11, v27
    v_lshlrev_b32 v10, 16, v174
    v_add_f32 v20, v20, v10
    v_fma_f32 v28, v10, v10, v28
    v_and_b32 v11, 0xffff0000, v174
    v_add_f32 v21, v21, v11
    v_fma_f32 v29, v11, v11, v29
    v_lshlrev_b32 v10, 16, v175
    v_add_f32 v22, v22, v10
    v_fma_f32 v30, v10, v10, v30
    v_and_b32 v11, 0xffff0000, v175
    v_add_f32 v23, v23, v11
    v_fma_f32 v31, v11, v11, v31
    s_waitcnt vmcnt(3)
    v_lshlrev_b32 v10, 16, v176
    v_add_f32 v16, v16, v10
    v_fma_f32 v24, v10, v10, v24
    v_and_b32 v11, 0xffff0000, v176
    v_add_f32 v17, v17, v11
    v_fma_f32 v25, v11, v11, v25
    v_lshlrev_b32 v10, 16, v177
    v_add_f32 v18, v18, v10
    v_fma_f32 v26, v10, v10, v26
    v_and_b32 v11, 0xffff0000, v177
    v_add_f32 v19, v19, v11
    v_fma_f32 v27, v11, v11, v27
    v_lshlrev_b32 v10, 16, v178
    v_add_f32 v20, v20, v10
    v_fma_f32 v28, v10, v10, v28
    v_and_b32 v11, 0xffff0000, v178
    v_add_f32 v21, v21, v11
    v_fma_f32 v29, v11, v11, v29
    v_lshlrev_b32 v10, 16, v179
    v_add_f32 v22, v22, v10
    v_fma_f32 v30, v10, v10, v30
    v_and_b32 v11, 0xffff0000, v179
    v_add_f32 v23, v23, v11
    v_fma_f32 v31, v11, v11, v31
    s_waitcnt vmcnt(2)
    v_lshlrev_b32 v10, 16, v180
    v_add_f32 v16, v16, v10
    v_fma_f32 v24, v10, v10, v24
    v_and_b32 v11, 0xffff0000, v180
    v_add_f32 v17, v17, v11
    v_fma_f32 v25, v11, v11, v25
    v_lshlrev_b32 v10, 16, v181
    v_add_f32 v18, v18, v10
    v_fma_f32 v26, v10, v10, v26
    v_and_b32 v11, 0xffff0000, v181
    v_add_f32 v19, v19, v11
    v_fma_f32 v27, v11, v11, v27
    v_lshlrev_b32 v10, 16, v182
    v_add_f32 v20, v20, v10
    v_fma_f32 v28, v10, v10, v28
    v_and_b32 v11, 0xffff0000, v182
    v_add_f32 v21, v21, v11
    v_fma_f32 v29, v11, v11, v29
    v_lshlrev_b32 v10, 16, v183
    v_add_f32 v22, v22, v10
    v_fma_f32 v30, v10, v10, v30
    v_and_b32 v11, 0xffff0000, v183
    v_add_f32 v23, v23, v11
    v_fma_f32 v31, v11, v11, v31
    s_waitcnt vmcnt(1)
    v_lshlrev_b32 v10, 16, v184
    v_add_f32 v16, v16, v10
    v_fma_f32 v24, v10, v10, v24
    v_and_b32 v11, 0xffff0000, v184
    v_add_f32 v17, v17, v11
    v_fma_f32 v25, v11, v11, v25
    v_lshlrev_b32 v10, 16, v185
    v_add_f32 v18, v18, v10
    v_fma_f32 v26, v10, v10, v26
    v_and_b32 v11, 0xffff0000, v185
    v_add_f32 v19, v19, v11
    v_fma_f32 v27, v11, v11, v27
    v_lshlrev_b32 v10, 16, v186
    v_add_f32 v20, v20, v10
    v_fma_f32 v28, v10, v10, v28
    v_and_b32 v11, 0xffff0000, v186
    v_add_f32 v21, v21, v11
    v_fma_f32 v29, v11, v11, v29
    v_lshlrev_b32 v10, 16, v187
    v_add_f32 v22, v22, v10
    v_fma_f32 v30, v10, v10, v30
    v_and_b32 v11, 0xffff0000, v187
    v_add_f32 v23, v23, v11
    v_fma_f32 v31, v11, v11, v31
    s_waitcnt vmcnt(0)
    v_lshlrev_b32 v10, 16, v188
    v_add_f32 v16, v16, v10
    v_fma_f32 v24, v10, v10, v24
    v_and_b32 v11, 0xffff0000, v188
    v_add_f32 v17, v17, v11
    v_fma_f32 v25, v11, v11, v25
    v_lshlrev_b32 v10, 16, v189
    v_add_f32 v18, v18, v10
    v_fma_f32 v26, v10, v10, v26
    v_and_b32 v11, 0xffff0000, v189
    v_add_f32 v19, v19, v11
    v_fma_f32 v27, v11, v11, v27
    v_lshlrev_b32 v10, 16, v190
    v_add_f32 v20, v20, v10
    v_fma_f32 v28, v10, v10, v28
    v_and_b32 v11, 0xffff0000, v190
    v_add_f32 v21, v21, v11
    v_fma_f32 v29, v11, v11, v29
    v_lshlrev_b32 v10, 16, v191
    v_add_f32 v22, v22, v10
    v_fma_f32 v30, v10, v10, v30
    v_and_b32 v11, 0xffff0000, v191
    v_add_f32 v23, v23, v11
    v_fma_f32 v31, v11, v11, v31
    v_lshlrev_b32 v10, 9, v7
    v_lshl_add_u32 v10, v6, 5, v10
    v_add_u32 v10, 0, v10
    ds_write_b128 v10, v[16:19]
    ds_write_b128 v10, v[20:23] offset:16
    ds_write_b128 v10, v[24:27] offset:256
    ds_write_b128 v10, v[28:31] offset:272
    s_waitcnt lgkmcnt(0)
    s_barrier
    v_cmp_gt_u32 vcc, 128, v0
    s_and_saveexec_b64 s[10:11], vcc
    v_lshlrev_b32 v10, 2, v0
    v_add_u32 v10, 0, v10
    ds_read_b32 v192, v10 offset:0
    ds_read_b32 v193, v10 offset:512
    ds_read_b32 v194, v10 offset:1024
    ds_read_b32 v195, v10 offset:1536
    ds_read_b32 v196, v10 offset:2048
    ds_read_b32 v197, v10 offset:2560
    ds_read_b32 v198, v10 offset:3072
    ds_read_b32 v199, v10 offset:3584
    ds_read_b32 v200, v10 offset:4096
    ds_read_b32 v201, v10 offset:4608
    ds_read_b32 v202, v10 offset:5120
    ds_read_b32 v203, v10 offset:5632
    ds_read_b32 v204, v10 offset:6144
    ds_read_b32 v205, v10 offset:6656
    ds_read_b32 v206, v10 offset:7168
    ds_read_b32 v207, v10 offset:7680
    ds_read_b32 v208, v10 offset:8192
    ds_read_b32 v209, v10 offset:8704
    ds_read_b32 v210, v10 offset:9216
    ds_read_b32 v211, v10 offset:9728
    ds_read_b32 v212, v10 offset:10240
    ds_read_b32 v213, v10 offset:10752
    ds_read_b32 v214, v10 offset:11264
    ds_read_b32 v215, v10 offset:11776
    ds_read_b32 v216, v10 offset:12288
    ds_read_b32 v217, v10 offset:12800
    ds_read_b32 v218, v10 offset:13312
    ds_read_b32 v219, v10 offset:13824
    ds_read_b32 v220, v10 offset:14336
    ds_read_b32 v221, v10 offset:14848
    ds_read_b32 v222, v10 offset:15360
    ds_read_b32 v223, v10 offset:15872
    s_waitcnt lgkmcnt(0)
    v_add_f32 v192, v192, v193
    v_add_f32 v192, v192, v194
    v_add_f32 v192, v192, v195
    v_add_f32 v192, v192, v196
    v_add_f32 v192, v192, v197
    v_add_f32 v192, v192, v198
    v_add_f32 v192, v192, v199
    v_add_f32 v192, v192, v200
    v_add_f32 v192, v192, v201
    v_add_f32 v192, v192, v202
    v_add_f32 v192, v192, v203
    v_add_f32 v192, v192, v204
    v_add_f32 v192, v192, v205
    v_add_f32 v192, v192, v206
    v_add_f32 v192, v192, v207
    v_add_f32 v192, v192, v208
    v_add_f32 v192, v192, v209
    v_add_f32 v192, v192, v210
    v_add_f32 v192, v192, v211
    v_add_f32 v192, v192, v212
    v_add_f32 v192, v192, v213
    v_add_f32 v192, v192, v214
    v_add_f32 v192, v192, v215
    v_add_f32 v192, v192, v216
    v_add_f32 v192, v192, v217
    v_add_f32 v192, v192, v218
    v_add_f32 v192, v192, v219
    v_add_f32 v192, v192, v220
    v_add_f32 v192, v192, v221
    v_add_f32 v192, v192, v222
    v_add_f32 v192, v192, v223
    ds_write_b32 v10, v192 offset:16384
    s_mov_b64 exec, s[10:11]
    s_waitcnt lgkmcnt(0)
    s_barrier
    v_lshlrev_b32 v10, 5, v6
    v_add_u32 v10, 16384, v10
    ds_read_b128 v[56:59], v10
    ds_read_b128 v[60:63], v10 offset:16
    ds_read_b128 v[48:51], v10 offset:256
    ds_read_b128 v[52:55], v10 offset:272
    s_waitcnt lgkmcnt(0)
    s_barrier
    s_mov_b32 s9, 0x3b000000
    s_mov_b32 s10, 0x3727c5ac
    v_mul_f32 v56, s9, v56
    v_mul_f32 v48, s9, v48
    v_fma_f32 v48, -v56, v56, v48
    v_max_f32 v48, 0, v48
    v_cvt_pk_bf16_f32 v48, v48, v48
    v_and_b32 v48, 0xffff0000, v48
    v_add_f32 v48, s10, v48
    v_cvt_pk_bf16_f32 v48, v48, v48
    v_and_b32 v48, 0xffff0000, v48
    v_sqrt_f32 v48, v48
    s_nop 0
    v_cvt_pk_bf16_f32 v48, v48, v48
    v_and_b32 v48, 0xffff0000, v48
    v_rcp_f32 v48, v48
    v_cvt_pk_bf16_f32 v56, v56, v56
    v_and_b32 v56, 0xffff0000, v56

    v_mul_f32 v57, s9, v57
    v_mul_f32 v49, s9, v49
    v_fma_f32 v49, -v57, v57, v49
    v_max_f32 v49, 0, v49
    v_cvt_pk_bf16_f32 v49, v49, v49
    v_and_b32 v49, 0xffff0000, v49
    v_add_f32 v49, s10, v49
    v_cvt_pk_bf16_f32 v49, v49, v49
    v_and_b32 v49, 0xffff0000, v49
    v_sqrt_f32 v49, v49
    s_nop 0
    v_cvt_pk_bf16_f32 v49, v49, v49
    v_and_b32 v49, 0xffff0000, v49
    v_rcp_f32 v49, v49
    v_cvt_pk_bf16_f32 v57, v57, v57
    v_and_b32 v57, 0xffff0000, v57

    v_mul_f32 v58, s9, v58
    v_mul_f32 v50, s9, v50
    v_fma_f32 v50, -v58, v58, v50
    v_max_f32 v50, 0, v50
    v_cvt_pk_bf16_f32 v50, v50, v50
    v_and_b32 v50, 0xffff0000, v50
    v_add_f32 v50, s10, v50
    v_cvt_pk_bf16_f32 v50, v50, v50
    v_and_b32 v50, 0xffff0000, v50
    v_sqrt_f32 v50, v50
    s_nop 0
    v_cvt_pk_bf16_f32 v50, v50, v50
    v_and_b32 v50, 0xffff0000, v50
    v_rcp_f32 v50, v50
    v_cvt_pk_bf16_f32 v58, v58, v58
    v_and_b32 v58, 0xffff0000, v58

    v_mul_f32 v59, s9, v59
    v_mul_f32 v51, s9, v51
    v_fma_f32 v51, -v59, v59, v51
    v_max_f32 v51, 0, v51
    v_cvt_pk_bf16_f32 v51, v51, v51
    v_and_b32 v51, 0xffff0000, v51
    v_add_f32 v51, s10, v51
    v_cvt_pk_bf16_f32 v51, v51, v51
    v_and_b32 v51, 0xffff0000, v51
    v_sqrt_f32 v51, v51
    s_nop 0
    v_cvt_pk_bf16_f32 v51, v51, v51
    v_and_b32 v51, 0xffff0000, v51
    v_rcp_f32 v51, v51
    v_cvt_pk_bf16_f32 v59, v59, v59
    v_and_b32 v59, 0xffff0000, v59

    v_mul_f32 v60, s9, v60
    v_mul_f32 v52, s9, v52
    v_fma_f32 v52, -v60, v60, v52
    v_max_f32 v52, 0, v52
    v_cvt_pk_bf16_f32 v52, v52, v52
    v_and_b32 v52, 0xffff0000, v52
    v_add_f32 v52, s10, v52
    v_cvt_pk_bf16_f32 v52, v52, v52
    v_and_b32 v52, 0xffff0000, v52
    v_sqrt_f32 v52, v52
    s_nop 0
    v_cvt_pk_bf16_f32 v52, v52, v52
    v_and_b32 v52, 0xffff0000, v52
    v_rcp_f32 v52, v52
    v_cvt_pk_bf16_f32 v60, v60, v60
    v_and_b32 v60, 0xffff0000, v60

    v_mul_f32 v61, s9, v61
    v_mul_f32 v53, s9, v53
    v_fma_f32 v53, -v61, v61, v53
    v_max_f32 v53, 0, v53
    v_cvt_pk_bf16_f32 v53, v53, v53
    v_and_b32 v53, 0xffff0000, v53
    v_add_f32 v53, s10, v53
    v_cvt_pk_bf16_f32 v53, v53, v53
    v_and_b32 v53, 0xffff0000, v53
    v_sqrt_f32 v53, v53
    s_nop 0
    v_cvt_pk_bf16_f32 v53, v53, v53
    v_and_b32 v53, 0xffff0000, v53
    v_rcp_f32 v53, v53
    v_cvt_pk_bf16_f32 v61, v61, v61
    v_and_b32 v61, 0xffff0000, v61

    v_mul_f32 v62, s9, v62
    v_mul_f32 v54, s9, v54
    v_fma_f32 v54, -v62, v62, v54
    v_max_f32 v54, 0, v54
    v_cvt_pk_bf16_f32 v54, v54, v54
    v_and_b32 v54, 0xffff0000, v54
    v_add_f32 v54, s10, v54
    v_cvt_pk_bf16_f32 v54, v54, v54
    v_and_b32 v54, 0xffff0000, v54
    v_sqrt_f32 v54, v54
    s_nop 0
    v_cvt_pk_bf16_f32 v54, v54, v54
    v_and_b32 v54, 0xffff0000, v54
    v_rcp_f32 v54, v54
    v_cvt_pk_bf16_f32 v62, v62, v62
    v_and_b32 v62, 0xffff0000, v62

    v_mul_f32 v63, s9, v63
    v_mul_f32 v55, s9, v55
    v_fma_f32 v55, -v63, v63, v55
    v_max_f32 v55, 0, v55
    v_cvt_pk_bf16_f32 v55, v55, v55
    v_and_b32 v55, 0xffff0000, v55
    v_add_f32 v55, s10, v55
    v_cvt_pk_bf16_f32 v55, v55, v55
    v_and_b32 v55, 0xffff0000, v55
    v_sqrt_f32 v55, v55
    s_nop 0
    v_cvt_pk_bf16_f32 v55, v55, v55
    v_and_b32 v55, 0xffff0000, v55
    v_rcp_f32 v55, v55
    v_cvt_pk_bf16_f32 v63, v63, v63
    v_and_b32 v63, 0xffff0000, v63

    v_lshrrev_b32 v12, 2, v7
    v_and_b32 v13, 3, v7
    v_lshlrev_b32 v13, 2, v13
    v_lshl_add_u32 v13, v6, 13, v13
    v_and_b32 v9, 1, v6
    v_lshlrev_b32 v9, 3, v9
    v_lshrrev_b32 v10, 1, v6
    v_lshlrev_b32 v10, 1, v10
    v_xor_b32 v9, v9, v10
    v_xor_b32 v14, 0, v9
    v_xor_b32 v14, v14, v12
    v_lshl_add_u32 v24, v14, 4, v13
    v_xor_b32 v192, 128, v24
    v_xor_b32 v14, 1, v9
    v_xor_b32 v14, v14, v12
    v_lshl_add_u32 v25, v14, 4, v13
    v_xor_b32 v193, 128, v25
    v_xor_b32 v14, 2, v9
    v_xor_b32 v14, v14, v12
    v_lshl_add_u32 v26, v14, 4, v13
    v_xor_b32 v194, 128, v26
    v_xor_b32 v14, 3, v9
    v_xor_b32 v14, v14, v12
    v_lshl_add_u32 v27, v14, 4, v13
    v_xor_b32 v195, 128, v27
    v_xor_b32 v14, 4, v9
    v_xor_b32 v14, v14, v12
    v_lshl_add_u32 v28, v14, 4, v13
    v_xor_b32 v196, 128, v28
    v_xor_b32 v14, 5, v9
    v_xor_b32 v14, v14, v12
    v_lshl_add_u32 v29, v14, 4, v13
    v_xor_b32 v197, 128, v29
    v_xor_b32 v14, 6, v9
    v_xor_b32 v14, v14, v12
    v_lshl_add_u32 v30, v14, 4, v13
    v_xor_b32 v198, 128, v30
    v_xor_b32 v14, 7, v9
    v_xor_b32 v14, v14, v12
    v_lshl_add_u32 v31, v14, 4, v13
    v_xor_b32 v199, 128, v31
    v_lshlrev_b32 v11, 16, v128
    v_lshlrev_b32 v12, 16, v132
    v_sub_f32 v11, v11, v56
    v_sub_f32 v12, v12, v56
    v_cvt_pk_bf16_f32 v11, v11, v12
    v_lshlrev_b32 v12, 16, v11
    v_and_b32 v11, 0xffff0000, v11
    v_mul_f32 v12, v12, v48
    v_mul_f32 v11, v11, v48
    v_cvt_pk_bf16_f32 v11, v12, v11
    ds_write_b32 v24, v11 offset:0

    v_and_b32 v11, 0xffff0000, v128
    v_and_b32 v12, 0xffff0000, v132
    v_sub_f32 v11, v11, v57
    v_sub_f32 v12, v12, v57
    v_cvt_pk_bf16_f32 v11, v11, v12
    v_lshlrev_b32 v12, 16, v11
    v_and_b32 v11, 0xffff0000, v11
    v_mul_f32 v12, v12, v49
    v_mul_f32 v11, v11, v49
    v_cvt_pk_bf16_f32 v11, v12, v11
    ds_write_b32 v25, v11 offset:1024

    v_lshlrev_b32 v11, 16, v129
    v_lshlrev_b32 v12, 16, v133
    v_sub_f32 v11, v11, v58
    v_sub_f32 v12, v12, v58
    v_cvt_pk_bf16_f32 v11, v11, v12
    v_lshlrev_b32 v12, 16, v11
    v_and_b32 v11, 0xffff0000, v11
    v_mul_f32 v12, v12, v50
    v_mul_f32 v11, v11, v50
    v_cvt_pk_bf16_f32 v11, v12, v11
    ds_write_b32 v26, v11 offset:2048

    v_and_b32 v11, 0xffff0000, v129
    v_and_b32 v12, 0xffff0000, v133
    v_sub_f32 v11, v11, v59
    v_sub_f32 v12, v12, v59
    v_cvt_pk_bf16_f32 v11, v11, v12
    v_lshlrev_b32 v12, 16, v11
    v_and_b32 v11, 0xffff0000, v11
    v_mul_f32 v12, v12, v51
    v_mul_f32 v11, v11, v51
    v_cvt_pk_bf16_f32 v11, v12, v11
    ds_write_b32 v27, v11 offset:3072

    v_lshlrev_b32 v11, 16, v130
    v_lshlrev_b32 v12, 16, v134
    v_sub_f32 v11, v11, v60
    v_sub_f32 v12, v12, v60
    v_cvt_pk_bf16_f32 v11, v11, v12
    v_lshlrev_b32 v12, 16, v11
    v_and_b32 v11, 0xffff0000, v11
    v_mul_f32 v12, v12, v52
    v_mul_f32 v11, v11, v52
    v_cvt_pk_bf16_f32 v11, v12, v11
    ds_write_b32 v28, v11 offset:4096

    v_and_b32 v11, 0xffff0000, v130
    v_and_b32 v12, 0xffff0000, v134
    v_sub_f32 v11, v11, v61
    v_sub_f32 v12, v12, v61
    v_cvt_pk_bf16_f32 v11, v11, v12
    v_lshlrev_b32 v12, 16, v11
    v_and_b32 v11, 0xffff0000, v11
    v_mul_f32 v12, v12, v53
    v_mul_f32 v11, v11, v53
    v_cvt_pk_bf16_f32 v11, v12, v11
    ds_write_b32 v29, v11 offset:5120

    v_lshlrev_b32 v11, 16, v131
    v_lshlrev_b32 v12, 16, v135
    v_sub_f32 v11, v11, v62
    v_sub_f32 v12, v12, v62
    v_cvt_pk_bf16_f32 v11, v11, v12
    v_lshlrev_b32 v12, 16, v11
    v_and_b32 v11, 0xffff0000, v11
    v_mul_f32 v12, v12, v54
    v_mul_f32 v11, v11, v54
    v_cvt_pk_bf16_f32 v11, v12, v11
    ds_write_b32 v30, v11 offset:6144

    v_and_b32 v11, 0xffff0000, v131
    v_and_b32 v12, 0xffff0000, v135
    v_sub_f32 v11, v11, v63
    v_sub_f32 v12, v12, v63
    v_cvt_pk_bf16_f32 v11, v11, v12
    v_lshlrev_b32 v12, 16, v11
    v_and_b32 v11, 0xffff0000, v11
    v_mul_f32 v12, v12, v55
    v_mul_f32 v11, v11, v55
    v_cvt_pk_bf16_f32 v11, v12, v11
    ds_write_b32 v31, v11 offset:7168

    v_lshlrev_b32 v11, 16, v136
    v_lshlrev_b32 v12, 16, v140
    v_sub_f32 v11, v11, v56
    v_sub_f32 v12, v12, v56
    v_cvt_pk_bf16_f32 v11, v11, v12
    v_lshlrev_b32 v12, 16, v11
    v_and_b32 v11, 0xffff0000, v11
    v_mul_f32 v12, v12, v48
    v_mul_f32 v11, v11, v48
    v_cvt_pk_bf16_f32 v11, v12, v11
    ds_write_b32 v192, v11 offset:0

    v_and_b32 v11, 0xffff0000, v136
    v_and_b32 v12, 0xffff0000, v140
    v_sub_f32 v11, v11, v57
    v_sub_f32 v12, v12, v57
    v_cvt_pk_bf16_f32 v11, v11, v12
    v_lshlrev_b32 v12, 16, v11
    v_and_b32 v11, 0xffff0000, v11
    v_mul_f32 v12, v12, v49
    v_mul_f32 v11, v11, v49
    v_cvt_pk_bf16_f32 v11, v12, v11
    ds_write_b32 v193, v11 offset:1024

    v_lshlrev_b32 v11, 16, v137
    v_lshlrev_b32 v12, 16, v141
    v_sub_f32 v11, v11, v58
    v_sub_f32 v12, v12, v58
    v_cvt_pk_bf16_f32 v11, v11, v12
    v_lshlrev_b32 v12, 16, v11
    v_and_b32 v11, 0xffff0000, v11
    v_mul_f32 v12, v12, v50
    v_mul_f32 v11, v11, v50
    v_cvt_pk_bf16_f32 v11, v12, v11
    ds_write_b32 v194, v11 offset:2048

    v_and_b32 v11, 0xffff0000, v137
    v_and_b32 v12, 0xffff0000, v141
    v_sub_f32 v11, v11, v59
    v_sub_f32 v12, v12, v59
    v_cvt_pk_bf16_f32 v11, v11, v12
    v_lshlrev_b32 v12, 16, v11
    v_and_b32 v11, 0xffff0000, v11
    v_mul_f32 v12, v12, v51
    v_mul_f32 v11, v11, v51
    v_cvt_pk_bf16_f32 v11, v12, v11
    ds_write_b32 v195, v11 offset:3072

    v_lshlrev_b32 v11, 16, v138
    v_lshlrev_b32 v12, 16, v142
    v_sub_f32 v11, v11, v60
    v_sub_f32 v12, v12, v60
    v_cvt_pk_bf16_f32 v11, v11, v12
    v_lshlrev_b32 v12, 16, v11
    v_and_b32 v11, 0xffff0000, v11
    v_mul_f32 v12, v12, v52
    v_mul_f32 v11, v11, v52
    v_cvt_pk_bf16_f32 v11, v12, v11
    ds_write_b32 v196, v11 offset:4096

    v_and_b32 v11, 0xffff0000, v138
    v_and_b32 v12, 0xffff0000, v142
    v_sub_f32 v11, v11, v61
    v_sub_f32 v12, v12, v61
    v_cvt_pk_bf16_f32 v11, v11, v12
    v_lshlrev_b32 v12, 16, v11
    v_and_b32 v11, 0xffff0000, v11
    v_mul_f32 v12, v12, v53
    v_mul_f32 v11, v11, v53
    v_cvt_pk_bf16_f32 v11, v12, v11
    ds_write_b32 v197, v11 offset:5120

    v_lshlrev_b32 v11, 16, v139
    v_lshlrev_b32 v12, 16, v143
    v_sub_f32 v11, v11, v62
    v_sub_f32 v12, v12, v62
    v_cvt_pk_bf16_f32 v11, v11, v12
    v_lshlrev_b32 v12, 16, v11
    v_and_b32 v11, 0xffff0000, v11
    v_mul_f32 v12, v12, v54
    v_mul_f32 v11, v11, v54
    v_cvt_pk_bf16_f32 v11, v12, v11
    ds_write_b32 v198, v11 offset:6144

    v_and_b32 v11, 0xffff0000, v139
    v_and_b32 v12, 0xffff0000, v143
    v_sub_f32 v11, v11, v63
    v_sub_f32 v12, v12, v63
    v_cvt_pk_bf16_f32 v11, v11, v12
    v_lshlrev_b32 v12, 16, v11
    v_and_b32 v11, 0xffff0000, v11
    v_mul_f32 v12, v12, v55
    v_mul_f32 v11, v11, v55
    v_cvt_pk_bf16_f32 v11, v12, v11
    ds_write_b32 v199, v11 offset:7168

    v_lshlrev_b32 v11, 16, v144
    v_lshlrev_b32 v12, 16, v148
    v_sub_f32 v11, v11, v56
    v_sub_f32 v12, v12, v56
    v_cvt_pk_bf16_f32 v11, v11, v12
    v_lshlrev_b32 v12, 16, v11
    v_and_b32 v11, 0xffff0000, v11
    v_mul_f32 v12, v12, v48
    v_mul_f32 v11, v11, v48
    v_cvt_pk_bf16_f32 v11, v12, v11
    ds_write_b32 v24, v11 offset:256

    v_and_b32 v11, 0xffff0000, v144
    v_and_b32 v12, 0xffff0000, v148
    v_sub_f32 v11, v11, v57
    v_sub_f32 v12, v12, v57
    v_cvt_pk_bf16_f32 v11, v11, v12
    v_lshlrev_b32 v12, 16, v11
    v_and_b32 v11, 0xffff0000, v11
    v_mul_f32 v12, v12, v49
    v_mul_f32 v11, v11, v49
    v_cvt_pk_bf16_f32 v11, v12, v11
    ds_write_b32 v25, v11 offset:1280

    v_lshlrev_b32 v11, 16, v145
    v_lshlrev_b32 v12, 16, v149
    v_sub_f32 v11, v11, v58
    v_sub_f32 v12, v12, v58
    v_cvt_pk_bf16_f32 v11, v11, v12
    v_lshlrev_b32 v12, 16, v11
    v_and_b32 v11, 0xffff0000, v11
    v_mul_f32 v12, v12, v50
    v_mul_f32 v11, v11, v50
    v_cvt_pk_bf16_f32 v11, v12, v11
    ds_write_b32 v26, v11 offset:2304

    v_and_b32 v11, 0xffff0000, v145
    v_and_b32 v12, 0xffff0000, v149
    v_sub_f32 v11, v11, v59
    v_sub_f32 v12, v12, v59
    v_cvt_pk_bf16_f32 v11, v11, v12
    v_lshlrev_b32 v12, 16, v11
    v_and_b32 v11, 0xffff0000, v11
    v_mul_f32 v12, v12, v51
    v_mul_f32 v11, v11, v51
    v_cvt_pk_bf16_f32 v11, v12, v11
    ds_write_b32 v27, v11 offset:3328

    v_lshlrev_b32 v11, 16, v146
    v_lshlrev_b32 v12, 16, v150
    v_sub_f32 v11, v11, v60
    v_sub_f32 v12, v12, v60
    v_cvt_pk_bf16_f32 v11, v11, v12
    v_lshlrev_b32 v12, 16, v11
    v_and_b32 v11, 0xffff0000, v11
    v_mul_f32 v12, v12, v52
    v_mul_f32 v11, v11, v52
    v_cvt_pk_bf16_f32 v11, v12, v11
    ds_write_b32 v28, v11 offset:4352

    v_and_b32 v11, 0xffff0000, v146
    v_and_b32 v12, 0xffff0000, v150
    v_sub_f32 v11, v11, v61
    v_sub_f32 v12, v12, v61
    v_cvt_pk_bf16_f32 v11, v11, v12
    v_lshlrev_b32 v12, 16, v11
    v_and_b32 v11, 0xffff0000, v11
    v_mul_f32 v12, v12, v53
    v_mul_f32 v11, v11, v53
    v_cvt_pk_bf16_f32 v11, v12, v11
    ds_write_b32 v29, v11 offset:5376

    v_lshlrev_b32 v11, 16, v147
    v_lshlrev_b32 v12, 16, v151
    v_sub_f32 v11, v11, v62
    v_sub_f32 v12, v12, v62
    v_cvt_pk_bf16_f32 v11, v11, v12
    v_lshlrev_b32 v12, 16, v11
    v_and_b32 v11, 0xffff0000, v11
    v_mul_f32 v12, v12, v54
    v_mul_f32 v11, v11, v54
    v_cvt_pk_bf16_f32 v11, v12, v11
    ds_write_b32 v30, v11 offset:6400

    v_and_b32 v11, 0xffff0000, v147
    v_and_b32 v12, 0xffff0000, v151
    v_sub_f32 v11, v11, v63
    v_sub_f32 v12, v12, v63
    v_cvt_pk_bf16_f32 v11, v11, v12
    v_lshlrev_b32 v12, 16, v11
    v_and_b32 v11, 0xffff0000, v11
    v_mul_f32 v12, v12, v55
    v_mul_f32 v11, v11, v55
    v_cvt_pk_bf16_f32 v11, v12, v11
    ds_write_b32 v31, v11 offset:7424

    v_lshlrev_b32 v11, 16, v152
    v_lshlrev_b32 v12, 16, v156
    v_sub_f32 v11, v11, v56
    v_sub_f32 v12, v12, v56
    v_cvt_pk_bf16_f32 v11, v11, v12
    v_lshlrev_b32 v12, 16, v11
    v_and_b32 v11, 0xffff0000, v11
    v_mul_f32 v12, v12, v48
    v_mul_f32 v11, v11, v48
    v_cvt_pk_bf16_f32 v11, v12, v11
    ds_write_b32 v192, v11 offset:256

    v_and_b32 v11, 0xffff0000, v152
    v_and_b32 v12, 0xffff0000, v156
    v_sub_f32 v11, v11, v57
    v_sub_f32 v12, v12, v57
    v_cvt_pk_bf16_f32 v11, v11, v12
    v_lshlrev_b32 v12, 16, v11
    v_and_b32 v11, 0xffff0000, v11
    v_mul_f32 v12, v12, v49
    v_mul_f32 v11, v11, v49
    v_cvt_pk_bf16_f32 v11, v12, v11
    ds_write_b32 v193, v11 offset:1280

    v_lshlrev_b32 v11, 16, v153
    v_lshlrev_b32 v12, 16, v157
    v_sub_f32 v11, v11, v58
    v_sub_f32 v12, v12, v58
    v_cvt_pk_bf16_f32 v11, v11, v12
    v_lshlrev_b32 v12, 16, v11
    v_and_b32 v11, 0xffff0000, v11
    v_mul_f32 v12, v12, v50
    v_mul_f32 v11, v11, v50
    v_cvt_pk_bf16_f32 v11, v12, v11
    ds_write_b32 v194, v11 offset:2304

    v_and_b32 v11, 0xffff0000, v153
    v_and_b32 v12, 0xffff0000, v157
    v_sub_f32 v11, v11, v59
    v_sub_f32 v12, v12, v59
    v_cvt_pk_bf16_f32 v11, v11, v12
    v_lshlrev_b32 v12, 16, v11
    v_and_b32 v11, 0xffff0000, v11
    v_mul_f32 v12, v12, v51
    v_mul_f32 v11, v11, v51
    v_cvt_pk_bf16_f32 v11, v12, v11
    ds_write_b32 v195, v11 offset:3328

    v_lshlrev_b32 v11, 16, v154
    v_lshlrev_b32 v12, 16, v158
    v_sub_f32 v11, v11, v60
    v_sub_f32 v12, v12, v60
    v_cvt_pk_bf16_f32 v11, v11, v12
    v_lshlrev_b32 v12, 16, v11
    v_and_b32 v11, 0xffff0000, v11
    v_mul_f32 v12, v12, v52
    v_mul_f32 v11, v11, v52
    v_cvt_pk_bf16_f32 v11, v12, v11
    ds_write_b32 v196, v11 offset:4352

    v_and_b32 v11, 0xffff0000, v154
    v_and_b32 v12, 0xffff0000, v158
    v_sub_f32 v11, v11, v61
    v_sub_f32 v12, v12, v61
    v_cvt_pk_bf16_f32 v11, v11, v12
    v_lshlrev_b32 v12, 16, v11
    v_and_b32 v11, 0xffff0000, v11
    v_mul_f32 v12, v12, v53
    v_mul_f32 v11, v11, v53
    v_cvt_pk_bf16_f32 v11, v12, v11
    ds_write_b32 v197, v11 offset:5376

    v_lshlrev_b32 v11, 16, v155
    v_lshlrev_b32 v12, 16, v159
    v_sub_f32 v11, v11, v62
    v_sub_f32 v12, v12, v62
    v_cvt_pk_bf16_f32 v11, v11, v12
    v_lshlrev_b32 v12, 16, v11
    v_and_b32 v11, 0xffff0000, v11
    v_mul_f32 v12, v12, v54
    v_mul_f32 v11, v11, v54
    v_cvt_pk_bf16_f32 v11, v12, v11
    ds_write_b32 v198, v11 offset:6400

    v_and_b32 v11, 0xffff0000, v155
    v_and_b32 v12, 0xffff0000, v159
    v_sub_f32 v11, v11, v63
    v_sub_f32 v12, v12, v63
    v_cvt_pk_bf16_f32 v11, v11, v12
    v_lshlrev_b32 v12, 16, v11
    v_and_b32 v11, 0xffff0000, v11
    v_mul_f32 v12, v12, v55
    v_mul_f32 v11, v11, v55
    v_cvt_pk_bf16_f32 v11, v12, v11
    ds_write_b32 v199, v11 offset:7424

    v_lshlrev_b32 v11, 16, v160
    v_lshlrev_b32 v12, 16, v164
    v_sub_f32 v11, v11, v56
    v_sub_f32 v12, v12, v56
    v_cvt_pk_bf16_f32 v11, v11, v12
    v_lshlrev_b32 v12, 16, v11
    v_and_b32 v11, 0xffff0000, v11
    v_mul_f32 v12, v12, v48
    v_mul_f32 v11, v11, v48
    v_cvt_pk_bf16_f32 v11, v12, v11
    ds_write_b32 v24, v11 offset:512

    v_and_b32 v11, 0xffff0000, v160
    v_and_b32 v12, 0xffff0000, v164
    v_sub_f32 v11, v11, v57
    v_sub_f32 v12, v12, v57
    v_cvt_pk_bf16_f32 v11, v11, v12
    v_lshlrev_b32 v12, 16, v11
    v_and_b32 v11, 0xffff0000, v11
    v_mul_f32 v12, v12, v49
    v_mul_f32 v11, v11, v49
    v_cvt_pk_bf16_f32 v11, v12, v11
    ds_write_b32 v25, v11 offset:1536

    v_lshlrev_b32 v11, 16, v161
    v_lshlrev_b32 v12, 16, v165
    v_sub_f32 v11, v11, v58
    v_sub_f32 v12, v12, v58
    v_cvt_pk_bf16_f32 v11, v11, v12
    v_lshlrev_b32 v12, 16, v11
    v_and_b32 v11, 0xffff0000, v11
    v_mul_f32 v12, v12, v50
    v_mul_f32 v11, v11, v50
    v_cvt_pk_bf16_f32 v11, v12, v11
    ds_write_b32 v26, v11 offset:2560

    v_and_b32 v11, 0xffff0000, v161
    v_and_b32 v12, 0xffff0000, v165
    v_sub_f32 v11, v11, v59
    v_sub_f32 v12, v12, v59
    v_cvt_pk_bf16_f32 v11, v11, v12
    v_lshlrev_b32 v12, 16, v11
    v_and_b32 v11, 0xffff0000, v11
    v_mul_f32 v12, v12, v51
    v_mul_f32 v11, v11, v51
    v_cvt_pk_bf16_f32 v11, v12, v11
    ds_write_b32 v27, v11 offset:3584

    v_lshlrev_b32 v11, 16, v162
    v_lshlrev_b32 v12, 16, v166
    v_sub_f32 v11, v11, v60
    v_sub_f32 v12, v12, v60
    v_cvt_pk_bf16_f32 v11, v11, v12
    v_lshlrev_b32 v12, 16, v11
    v_and_b32 v11, 0xffff0000, v11
    v_mul_f32 v12, v12, v52
    v_mul_f32 v11, v11, v52
    v_cvt_pk_bf16_f32 v11, v12, v11
    ds_write_b32 v28, v11 offset:4608

    v_and_b32 v11, 0xffff0000, v162
    v_and_b32 v12, 0xffff0000, v166
    v_sub_f32 v11, v11, v61
    v_sub_f32 v12, v12, v61
    v_cvt_pk_bf16_f32 v11, v11, v12
    v_lshlrev_b32 v12, 16, v11
    v_and_b32 v11, 0xffff0000, v11
    v_mul_f32 v12, v12, v53
    v_mul_f32 v11, v11, v53
    v_cvt_pk_bf16_f32 v11, v12, v11
    ds_write_b32 v29, v11 offset:5632

    v_lshlrev_b32 v11, 16, v163
    v_lshlrev_b32 v12, 16, v167
    v_sub_f32 v11, v11, v62
    v_sub_f32 v12, v12, v62
    v_cvt_pk_bf16_f32 v11, v11, v12
    v_lshlrev_b32 v12, 16, v11
    v_and_b32 v11, 0xffff0000, v11
    v_mul_f32 v12, v12, v54
    v_mul_f32 v11, v11, v54
    v_cvt_pk_bf16_f32 v11, v12, v11
    ds_write_b32 v30, v11 offset:6656

    v_and_b32 v11, 0xffff0000, v163
    v_and_b32 v12, 0xffff0000, v167
    v_sub_f32 v11, v11, v63
    v_sub_f32 v12, v12, v63
    v_cvt_pk_bf16_f32 v11, v11, v12
    v_lshlrev_b32 v12, 16, v11
    v_and_b32 v11, 0xffff0000, v11
    v_mul_f32 v12, v12, v55
    v_mul_f32 v11, v11, v55
    v_cvt_pk_bf16_f32 v11, v12, v11
    ds_write_b32 v31, v11 offset:7680

    v_lshlrev_b32 v11, 16, v168
    v_lshlrev_b32 v12, 16, v172
    v_sub_f32 v11, v11, v56
    v_sub_f32 v12, v12, v56
    v_cvt_pk_bf16_f32 v11, v11, v12
    v_lshlrev_b32 v12, 16, v11
    v_and_b32 v11, 0xffff0000, v11
    v_mul_f32 v12, v12, v48
    v_mul_f32 v11, v11, v48
    v_cvt_pk_bf16_f32 v11, v12, v11
    ds_write_b32 v192, v11 offset:512

    v_and_b32 v11, 0xffff0000, v168
    v_and_b32 v12, 0xffff0000, v172
    v_sub_f32 v11, v11, v57
    v_sub_f32 v12, v12, v57
    v_cvt_pk_bf16_f32 v11, v11, v12
    v_lshlrev_b32 v12, 16, v11
    v_and_b32 v11, 0xffff0000, v11
    v_mul_f32 v12, v12, v49
    v_mul_f32 v11, v11, v49
    v_cvt_pk_bf16_f32 v11, v12, v11
    ds_write_b32 v193, v11 offset:1536

    v_lshlrev_b32 v11, 16, v169
    v_lshlrev_b32 v12, 16, v173
    v_sub_f32 v11, v11, v58
    v_sub_f32 v12, v12, v58
    v_cvt_pk_bf16_f32 v11, v11, v12
    v_lshlrev_b32 v12, 16, v11
    v_and_b32 v11, 0xffff0000, v11
    v_mul_f32 v12, v12, v50
    v_mul_f32 v11, v11, v50
    v_cvt_pk_bf16_f32 v11, v12, v11
    ds_write_b32 v194, v11 offset:2560

    v_and_b32 v11, 0xffff0000, v169
    v_and_b32 v12, 0xffff0000, v173
    v_sub_f32 v11, v11, v59
    v_sub_f32 v12, v12, v59
    v_cvt_pk_bf16_f32 v11, v11, v12
    v_lshlrev_b32 v12, 16, v11
    v_and_b32 v11, 0xffff0000, v11
    v_mul_f32 v12, v12, v51
    v_mul_f32 v11, v11, v51
    v_cvt_pk_bf16_f32 v11, v12, v11
    ds_write_b32 v195, v11 offset:3584

    v_lshlrev_b32 v11, 16, v170
    v_lshlrev_b32 v12, 16, v174
    v_sub_f32 v11, v11, v60
    v_sub_f32 v12, v12, v60
    v_cvt_pk_bf16_f32 v11, v11, v12
    v_lshlrev_b32 v12, 16, v11
    v_and_b32 v11, 0xffff0000, v11
    v_mul_f32 v12, v12, v52
    v_mul_f32 v11, v11, v52
    v_cvt_pk_bf16_f32 v11, v12, v11
    ds_write_b32 v196, v11 offset:4608

    v_and_b32 v11, 0xffff0000, v170
    v_and_b32 v12, 0xffff0000, v174
    v_sub_f32 v11, v11, v61
    v_sub_f32 v12, v12, v61
    v_cvt_pk_bf16_f32 v11, v11, v12
    v_lshlrev_b32 v12, 16, v11
    v_and_b32 v11, 0xffff0000, v11
    v_mul_f32 v12, v12, v53
    v_mul_f32 v11, v11, v53
    v_cvt_pk_bf16_f32 v11, v12, v11
    ds_write_b32 v197, v11 offset:5632

    v_lshlrev_b32 v11, 16, v171
    v_lshlrev_b32 v12, 16, v175
    v_sub_f32 v11, v11, v62
    v_sub_f32 v12, v12, v62
    v_cvt_pk_bf16_f32 v11, v11, v12
    v_lshlrev_b32 v12, 16, v11
    v_and_b32 v11, 0xffff0000, v11
    v_mul_f32 v12, v12, v54
    v_mul_f32 v11, v11, v54
    v_cvt_pk_bf16_f32 v11, v12, v11
    ds_write_b32 v198, v11 offset:6656

    v_and_b32 v11, 0xffff0000, v171
    v_and_b32 v12, 0xffff0000, v175
    v_sub_f32 v11, v11, v63
    v_sub_f32 v12, v12, v63
    v_cvt_pk_bf16_f32 v11, v11, v12
    v_lshlrev_b32 v12, 16, v11
    v_and_b32 v11, 0xffff0000, v11
    v_mul_f32 v12, v12, v55
    v_mul_f32 v11, v11, v55
    v_cvt_pk_bf16_f32 v11, v12, v11
    ds_write_b32 v199, v11 offset:7680

    v_lshlrev_b32 v11, 16, v176
    v_lshlrev_b32 v12, 16, v180
    v_sub_f32 v11, v11, v56
    v_sub_f32 v12, v12, v56
    v_cvt_pk_bf16_f32 v11, v11, v12
    v_lshlrev_b32 v12, 16, v11
    v_and_b32 v11, 0xffff0000, v11
    v_mul_f32 v12, v12, v48
    v_mul_f32 v11, v11, v48
    v_cvt_pk_bf16_f32 v11, v12, v11
    ds_write_b32 v24, v11 offset:768

    v_and_b32 v11, 0xffff0000, v176
    v_and_b32 v12, 0xffff0000, v180
    v_sub_f32 v11, v11, v57
    v_sub_f32 v12, v12, v57
    v_cvt_pk_bf16_f32 v11, v11, v12
    v_lshlrev_b32 v12, 16, v11
    v_and_b32 v11, 0xffff0000, v11
    v_mul_f32 v12, v12, v49
    v_mul_f32 v11, v11, v49
    v_cvt_pk_bf16_f32 v11, v12, v11
    ds_write_b32 v25, v11 offset:1792

    v_lshlrev_b32 v11, 16, v177
    v_lshlrev_b32 v12, 16, v181
    v_sub_f32 v11, v11, v58
    v_sub_f32 v12, v12, v58
    v_cvt_pk_bf16_f32 v11, v11, v12
    v_lshlrev_b32 v12, 16, v11
    v_and_b32 v11, 0xffff0000, v11
    v_mul_f32 v12, v12, v50
    v_mul_f32 v11, v11, v50
    v_cvt_pk_bf16_f32 v11, v12, v11
    ds_write_b32 v26, v11 offset:2816

    v_and_b32 v11, 0xffff0000, v177
    v_and_b32 v12, 0xffff0000, v181
    v_sub_f32 v11, v11, v59
    v_sub_f32 v12, v12, v59
    v_cvt_pk_bf16_f32 v11, v11, v12
    v_lshlrev_b32 v12, 16, v11
    v_and_b32 v11, 0xffff0000, v11
    v_mul_f32 v12, v12, v51
    v_mul_f32 v11, v11, v51
    v_cvt_pk_bf16_f32 v11, v12, v11
    ds_write_b32 v27, v11 offset:3840

    v_lshlrev_b32 v11, 16, v178
    v_lshlrev_b32 v12, 16, v182
    v_sub_f32 v11, v11, v60
    v_sub_f32 v12, v12, v60
    v_cvt_pk_bf16_f32 v11, v11, v12
    v_lshlrev_b32 v12, 16, v11
    v_and_b32 v11, 0xffff0000, v11
    v_mul_f32 v12, v12, v52
    v_mul_f32 v11, v11, v52
    v_cvt_pk_bf16_f32 v11, v12, v11
    ds_write_b32 v28, v11 offset:4864

    v_and_b32 v11, 0xffff0000, v178
    v_and_b32 v12, 0xffff0000, v182
    v_sub_f32 v11, v11, v61
    v_sub_f32 v12, v12, v61
    v_cvt_pk_bf16_f32 v11, v11, v12
    v_lshlrev_b32 v12, 16, v11
    v_and_b32 v11, 0xffff0000, v11
    v_mul_f32 v12, v12, v53
    v_mul_f32 v11, v11, v53
    v_cvt_pk_bf16_f32 v11, v12, v11
    ds_write_b32 v29, v11 offset:5888

    v_lshlrev_b32 v11, 16, v179
    v_lshlrev_b32 v12, 16, v183
    v_sub_f32 v11, v11, v62
    v_sub_f32 v12, v12, v62
    v_cvt_pk_bf16_f32 v11, v11, v12
    v_lshlrev_b32 v12, 16, v11
    v_and_b32 v11, 0xffff0000, v11
    v_mul_f32 v12, v12, v54
    v_mul_f32 v11, v11, v54
    v_cvt_pk_bf16_f32 v11, v12, v11
    ds_write_b32 v30, v11 offset:6912

    v_and_b32 v11, 0xffff0000, v179
    v_and_b32 v12, 0xffff0000, v183
    v_sub_f32 v11, v11, v63
    v_sub_f32 v12, v12, v63
    v_cvt_pk_bf16_f32 v11, v11, v12
    v_lshlrev_b32 v12, 16, v11
    v_and_b32 v11, 0xffff0000, v11
    v_mul_f32 v12, v12, v55
    v_mul_f32 v11, v11, v55
    v_cvt_pk_bf16_f32 v11, v12, v11
    ds_write_b32 v31, v11 offset:7936

    v_lshlrev_b32 v11, 16, v184
    v_lshlrev_b32 v12, 16, v188
    v_sub_f32 v11, v11, v56
    v_sub_f32 v12, v12, v56
    v_cvt_pk_bf16_f32 v11, v11, v12
    v_lshlrev_b32 v12, 16, v11
    v_and_b32 v11, 0xffff0000, v11
    v_mul_f32 v12, v12, v48
    v_mul_f32 v11, v11, v48
    v_cvt_pk_bf16_f32 v11, v12, v11
    ds_write_b32 v192, v11 offset:768

    v_and_b32 v11, 0xffff0000, v184
    v_and_b32 v12, 0xffff0000, v188
    v_sub_f32 v11, v11, v57
    v_sub_f32 v12, v12, v57
    v_cvt_pk_bf16_f32 v11, v11, v12
    v_lshlrev_b32 v12, 16, v11
    v_and_b32 v11, 0xffff0000, v11
    v_mul_f32 v12, v12, v49
    v_mul_f32 v11, v11, v49
    v_cvt_pk_bf16_f32 v11, v12, v11
    ds_write_b32 v193, v11 offset:1792

    v_lshlrev_b32 v11, 16, v185
    v_lshlrev_b32 v12, 16, v189
    v_sub_f32 v11, v11, v58
    v_sub_f32 v12, v12, v58
    v_cvt_pk_bf16_f32 v11, v11, v12
    v_lshlrev_b32 v12, 16, v11
    v_and_b32 v11, 0xffff0000, v11
    v_mul_f32 v12, v12, v50
    v_mul_f32 v11, v11, v50
    v_cvt_pk_bf16_f32 v11, v12, v11
    ds_write_b32 v194, v11 offset:2816

    v_and_b32 v11, 0xffff0000, v185
    v_and_b32 v12, 0xffff0000, v189
    v_sub_f32 v11, v11, v59
    v_sub_f32 v12, v12, v59
    v_cvt_pk_bf16_f32 v11, v11, v12
    v_lshlrev_b32 v12, 16, v11
    v_and_b32 v11, 0xffff0000, v11
    v_mul_f32 v12, v12, v51
    v_mul_f32 v11, v11, v51
    v_cvt_pk_bf16_f32 v11, v12, v11
    ds_write_b32 v195, v11 offset:3840

    v_lshlrev_b32 v11, 16, v186
    v_lshlrev_b32 v12, 16, v190
    v_sub_f32 v11, v11, v60
    v_sub_f32 v12, v12, v60
    v_cvt_pk_bf16_f32 v11, v11, v12
    v_lshlrev_b32 v12, 16, v11
    v_and_b32 v11, 0xffff0000, v11
    v_mul_f32 v12, v12, v52
    v_mul_f32 v11, v11, v52
    v_cvt_pk_bf16_f32 v11, v12, v11
    ds_write_b32 v196, v11 offset:4864

    v_and_b32 v11, 0xffff0000, v186
    v_and_b32 v12, 0xffff0000, v190
    v_sub_f32 v11, v11, v61
    v_sub_f32 v12, v12, v61
    v_cvt_pk_bf16_f32 v11, v11, v12
    v_lshlrev_b32 v12, 16, v11
    v_and_b32 v11, 0xffff0000, v11
    v_mul_f32 v12, v12, v53
    v_mul_f32 v11, v11, v53
    v_cvt_pk_bf16_f32 v11, v12, v11
    ds_write_b32 v197, v11 offset:5888

    v_lshlrev_b32 v11, 16, v187
    v_lshlrev_b32 v12, 16, v191
    v_sub_f32 v11, v11, v62
    v_sub_f32 v12, v12, v62
    v_cvt_pk_bf16_f32 v11, v11, v12
    v_lshlrev_b32 v12, 16, v11
    v_and_b32 v11, 0xffff0000, v11
    v_mul_f32 v12, v12, v54
    v_mul_f32 v11, v11, v54
    v_cvt_pk_bf16_f32 v11, v12, v11
    ds_write_b32 v198, v11 offset:6912

    v_and_b32 v11, 0xffff0000, v187
    v_and_b32 v12, 0xffff0000, v191
    v_sub_f32 v11, v11, v63
    v_sub_f32 v12, v12, v63
    v_cvt_pk_bf16_f32 v11, v11, v12
    v_lshlrev_b32 v12, 16, v11
    v_and_b32 v11, 0xffff0000, v11
    v_mul_f32 v12, v12, v55
    v_mul_f32 v11, v11, v55
    v_cvt_pk_bf16_f32 v11, v12, v11
    ds_write_b32 v199, v11 offset:7936

    v_add_u32 v11, 0, v2
    v_lshrrev_b32 v12, 4, v11
    v_and_b32 v12, 3, v12
    v_lshlrev_b32 v12, 1, v12
    v_and_b32 v13, 15, v11
    v_xor_b32 v12, v12, v13
    v_lshl_add_u32 v13, v3, 2, 0
    v_xor_b32 v13, v13, v12
    v_lshlrev_b32 v13, 4, v13
    v_lshl_add_u32 v16, v11, 10, v13
    v_lshl_add_u32 v13, v3, 2, 1
    v_xor_b32 v13, v13, v12
    v_lshlrev_b32 v13, 4, v13
    v_lshl_add_u32 v17, v11, 10, v13
    v_lshl_add_u32 v13, v3, 2, 2
    v_xor_b32 v13, v13, v12
    v_lshlrev_b32 v13, 4, v13
    v_lshl_add_u32 v18, v11, 10, v13
    v_lshl_add_u32 v13, v3, 2, 3
    v_xor_b32 v13, v13, v12
    v_lshlrev_b32 v13, 4, v13
    v_lshl_add_u32 v19, v11, 10, v13
    v_add_u32 v11, 32, v2
    v_lshrrev_b32 v12, 4, v11
    v_and_b32 v12, 3, v12
    v_lshlrev_b32 v12, 1, v12
    v_and_b32 v13, 15, v11
    v_xor_b32 v12, v12, v13
    v_lshl_add_u32 v13, v3, 2, 0
    v_xor_b32 v13, v13, v12
    v_lshlrev_b32 v13, 4, v13
    v_lshl_add_u32 v20, v11, 10, v13
    v_lshl_add_u32 v13, v3, 2, 1
    v_xor_b32 v13, v13, v12
    v_lshlrev_b32 v13, 4, v13
    v_lshl_add_u32 v21, v11, 10, v13
    v_lshl_add_u32 v13, v3, 2, 2
    v_xor_b32 v13, v13, v12
    v_lshlrev_b32 v13, 4, v13
    v_lshl_add_u32 v22, v11, 10, v13
    v_lshl_add_u32 v13, v3, 2, 3
    v_xor_b32 v13, v13, v12
    v_lshlrev_b32 v13, 4, v13
    v_lshl_add_u32 v23, v11, 10, v13
    v_mov_b32 v160, 0
    v_mov_b32 v161, 0
    v_mov_b32 v162, 0
    v_mov_b32 v163, 0
    v_mov_b32 v164, 0
    v_mov_b32 v165, 0
    v_mov_b32 v166, 0
    v_mov_b32 v167, 0
    v_mov_b32 v168, 0
    v_mov_b32 v169, 0
    v_mov_b32 v170, 0
    v_mov_b32 v171, 0
    v_mov_b32 v172, 0
    v_mov_b32 v173, 0
    v_mov_b32 v174, 0
    v_mov_b32 v175, 0
    v_mov_b32 v176, 0
    v_mov_b32 v177, 0
    v_mov_b32 v178, 0
    v_mov_b32 v179, 0
    v_mov_b32 v180, 0
    v_mov_b32 v181, 0
    v_mov_b32 v182, 0
    v_mov_b32 v183, 0
    v_mov_b32 v184, 0
    v_mov_b32 v185, 0
    v_mov_b32 v186, 0
    v_mov_b32 v187, 0
    v_mov_b32 v188, 0
    v_mov_b32 v189, 0
    v_mov_b32 v190, 0
    v_mov_b32 v191, 0
    v_mov_b32 v192, 0
    v_mov_b32 v193, 0
    v_mov_b32 v194, 0
    v_mov_b32 v195, 0
    v_mov_b32 v196, 0
    v_mov_b32 v197, 0
    v_mov_b32 v198, 0
    v_mov_b32 v199, 0
    v_mov_b32 v200, 0
    v_mov_b32 v201, 0
    v_mov_b32 v202, 0
    v_mov_b32 v203, 0
    v_mov_b32 v204, 0
    v_mov_b32 v205, 0
    v_mov_b32 v206, 0
    v_mov_b32 v207, 0
    v_mov_b32 v208, 0
    v_mov_b32 v209, 0
    v_mov_b32 v210, 0
    v_mov_b32 v211, 0
    v_mov_b32 v212, 0
    v_mov_b32 v213, 0
    v_mov_b32 v214, 0
    v_mov_b32 v215, 0
    v_mov_b32 v216, 0
    v_mov_b32 v217, 0
    v_mov_b32 v218, 0
    v_mov_b32 v219, 0
    v_mov_b32 v220, 0
    v_mov_b32 v221, 0
    v_mov_b32 v222, 0
    v_mov_b32 v223, 0
    v_lshrrev_b32 v12, 1, v2
    v_and_b32 v12, 7, v12
    s_lshl_b32 s9, s3, 13
    s_add_u32 s9, s9, 0x10000
    v_lshl_add_u32 v13, v3, 2, 0
    v_xor_b32 v13, v13, v12
    v_lshlrev_b32 v13, 4, v13
    v_lshl_add_u32 v40, v2, 7, v13
    v_add_u32 v40, s9, v40
    v_lshl_add_u32 v13, v3, 2, 1
    v_xor_b32 v13, v13, v12
    v_lshlrev_b32 v13, 4, v13
    v_lshl_add_u32 v41, v2, 7, v13
    v_add_u32 v41, s9, v41
    v_lshl_add_u32 v13, v3, 2, 2
    v_xor_b32 v13, v13, v12
    v_lshlrev_b32 v13, 4, v13
    v_lshl_add_u32 v42, v2, 7, v13
    v_add_u32 v42, s9, v42
    v_lshl_add_u32 v13, v3, 2, 3
    v_xor_b32 v13, v13, v12
    v_lshlrev_b32 v13, 4, v13
    v_lshl_add_u32 v43, v2, 7, v13
    v_add_u32 v43, s9, v43
    s_mov_b32 s17, 0
    s_mov_b32 s14, 8
K3_L:
    s_waitcnt vmcnt(8) lgkmcnt(0)
    s_barrier
    v_add_u32 v48, s17, v40
    v_add_u32 v49, s17, v41
    v_add_u32 v50, s17, v42
    v_add_u32 v51, s17, v43
    ds_read_b128 v[128:131], v16
    ds_read_b128 v[144:147], v20
    ds_read_b128 v[96:99], v48 offset:0
    ds_read_b128 v[112:115], v48 offset:4096
    ds_read_b128 v[132:135], v17
    ds_read_b128 v[148:151], v21
    ds_read_b128 v[100:103], v49 offset:0
    ds_read_b128 v[116:119], v49 offset:4096
    ds_read_b128 v[136:139], v18
    ds_read_b128 v[152:155], v22
    ds_read_b128 v[104:107], v50 offset:0
    ds_read_b128 v[120:123], v50 offset:4096
    ds_read_b128 v[140:143], v19
    ds_read_b128 v[156:159], v23
    ds_read_b128 v[108:111], v51 offset:0
    ds_read_b128 v[124:127], v51 offset:4096
    s_add_u32 s12, s16, s7
    s_add_u32 m0, s12, 0
    s_nop 0
    buffer_load_dwordx4 v32, s[40:43], s13 offen lds
    s_add_u32 m0, s12, 1024
    s_nop 0
    buffer_load_dwordx4 v33, s[40:43], s13 offen lds
    s_add_u32 m0, s12, 2048
    s_nop 0
    buffer_load_dwordx4 v34, s[40:43], s13 offen lds
    s_add_u32 m0, s12, 3072
    s_nop 0
    buffer_load_dwordx4 v35, s[40:43], s13 offen lds
    s_add_u32 m0, s12, 4096
    s_nop 0
    buffer_load_dwordx4 v36, s[40:43], s13 offen lds
    s_add_u32 m0, s12, 5120
    s_nop 0
    buffer_load_dwordx4 v37, s[40:43], s13 offen lds
    s_add_u32 m0, s12, 6144
    s_nop 0
    buffer_load_dwordx4 v38, s[40:43], s13 offen lds
    s_add_u32 m0, s12, 7168
    s_nop 0
    buffer_load_dwordx4 v39, s[40:43], s13 offen lds
    s_add_u32 s13, s13, 128
    s_add_u32 s16, s16, 32768
    s_cmp_eq_u32 s16, 98304
    s_cselect_b32 s16, 0, s16
    s_add_u32 s17, s17, 32768
    s_cmp_eq_u32 s17, 98304
    s_cselect_b32 s17, 0, s17
    s_waitcnt lgkmcnt(12)
    v_mfma_f32_32x32x16_bf16 v[160:175], v[128:131], v[96:99], v[160:175]
    v_mfma_f32_32x32x16_bf16 v[176:191], v[128:131], v[112:115], v[176:191]
    v_mfma_f32_32x32x16_bf16 v[192:207], v[144:147], v[96:99], v[192:207]
    v_mfma_f32_32x32x16_bf16 v[208:223], v[144:147], v[112:115], v[208:223]
    s_waitcnt lgkmcnt(8)
    v_mfma_f32_32x32x16_bf16 v[160:175], v[132:135], v[100:103], v[160:175]
    v_mfma_f32_32x32x16_bf16 v[176:191], v[132:135], v[116:119], v[176:191]
    v_mfma_f32_32x32x16_bf16 v[192:207], v[148:151], v[100:103], v[192:207]
    v_mfma_f32_32x32x16_bf16 v[208:223], v[148:151], v[116:119], v[208:223]
    s_waitcnt lgkmcnt(4)
    v_mfma_f32_32x32x16_bf16 v[160:175], v[136:139], v[104:107], v[160:175]
    v_mfma_f32_32x32x16_bf16 v[176:191], v[136:139], v[120:123], v[176:191]
    v_mfma_f32_32x32x16_bf16 v[192:207], v[152:155], v[104:107], v[192:207]
    v_mfma_f32_32x32x16_bf16 v[208:223], v[152:155], v[120:123], v[208:223]
    s_waitcnt lgkmcnt(0)
    v_mfma_f32_32x32x16_bf16 v[160:175], v[140:143], v[108:111], v[160:175]
    v_mfma_f32_32x32x16_bf16 v[176:191], v[140:143], v[124:127], v[176:191]
    v_mfma_f32_32x32x16_bf16 v[192:207], v[156:159], v[108:111], v[192:207]
    v_mfma_f32_32x32x16_bf16 v[208:223], v[156:159], v[124:127], v[208:223]
    s_and_b32 s18, s14, 1
    s_lshl_b32 s18, s18, 8
    v_xor_b32 v16, 128, v16
    v_add_u32 v16, s18, v16
    v_xor_b32 v17, 128, v17
    v_add_u32 v17, s18, v17
    v_xor_b32 v18, 128, v18
    v_add_u32 v18, s18, v18
    v_xor_b32 v19, 128, v19
    v_add_u32 v19, s18, v19
    v_xor_b32 v20, 128, v20
    v_add_u32 v20, s18, v20
    v_xor_b32 v21, 128, v21
    v_add_u32 v21, s18, v21
    v_xor_b32 v22, 128, v22
    v_add_u32 v22, s18, v22
    v_xor_b32 v23, 128, v23
    v_add_u32 v23, s18, v23
    s_sub_u32 s14, s14, 1
    s_cmp_lg_u32 s14, 0
    s_cbranch_scc1 K3_L
    s_nop 15
    s_waitcnt vmcnt(0) lgkmcnt(0)
    s_barrier
    v_lshlrev_b32 v11, 2, v3
    s_movk_i32 s9, 1040
    v_mul_lo_u32 v11, v11, s9
    v_lshl_add_u32 v11, v2, 2, v11
    s_lshl_b32 s9, s3, 8
    v_add_u32 v11, s9, v11
    v_add_u32 v12, 33280, v11
    ds_write_b32 v11, v160 offset:0
    ds_write_b32 v11, v161 offset:1040
    ds_write_b32 v11, v162 offset:2080
    ds_write_b32 v11, v163 offset:3120
    ds_write_b32 v11, v164 offset:8320
    ds_write_b32 v11, v165 offset:9360
    ds_write_b32 v11, v166 offset:10400
    ds_write_b32 v11, v167 offset:11440
    ds_write_b32 v11, v168 offset:16640
    ds_write_b32 v11, v169 offset:17680
    ds_write_b32 v11, v170 offset:18720
    ds_write_b32 v11, v171 offset:19760
    ds_write_b32 v11, v172 offset:24960
    ds_write_b32 v11, v173 offset:26000
    ds_write_b32 v11, v174 offset:27040
    ds_write_b32 v11, v175 offset:28080
    ds_write_b32 v11, v176 offset:128
    ds_write_b32 v11, v177 offset:1168
    ds_write_b32 v11, v178 offset:2208
    ds_write_b32 v11, v179 offset:3248
    ds_write_b32 v11, v180 offset:8448
    ds_write_b32 v11, v181 offset:9488
    ds_write_b32 v11, v182 offset:10528
    ds_write_b32 v11, v183 offset:11568
    ds_write_b32 v11, v184 offset:16768
    ds_write_b32 v11, v185 offset:17808
    ds_write_b32 v11, v186 offset:18848
    ds_write_b32 v11, v187 offset:19888
    ds_write_b32 v11, v188 offset:25088
    ds_write_b32 v11, v189 offset:26128
    ds_write_b32 v11, v190 offset:27168
    ds_write_b32 v11, v191 offset:28208
    ds_write_b32 v12, v192 offset:0
    ds_write_b32 v12, v193 offset:1040
    ds_write_b32 v12, v194 offset:2080
    ds_write_b32 v12, v195 offset:3120
    ds_write_b32 v12, v196 offset:8320
    ds_write_b32 v12, v197 offset:9360
    ds_write_b32 v12, v198 offset:10400
    ds_write_b32 v12, v199 offset:11440
    ds_write_b32 v12, v200 offset:16640
    ds_write_b32 v12, v201 offset:17680
    ds_write_b32 v12, v202 offset:18720
    ds_write_b32 v12, v203 offset:19760
    ds_write_b32 v12, v204 offset:24960
    ds_write_b32 v12, v205 offset:26000
    ds_write_b32 v12, v206 offset:27040
    ds_write_b32 v12, v207 offset:28080
    ds_write_b32 v12, v208 offset:128
    ds_write_b32 v12, v209 offset:1168
    ds_write_b32 v12, v210 offset:2208
    ds_write_b32 v12, v211 offset:3248
    ds_write_b32 v12, v212 offset:8448
    ds_write_b32 v12, v213 offset:9488
    ds_write_b32 v12, v214 offset:10528
    ds_write_b32 v12, v215 offset:11568
    ds_write_b32 v12, v216 offset:16768
    ds_write_b32 v12, v217 offset:17808
    ds_write_b32 v12, v218 offset:18848
    ds_write_b32 v12, v219 offset:19888
    ds_write_b32 v12, v220 offset:25088
    ds_write_b32 v12, v221 offset:26128
    ds_write_b32 v12, v222 offset:27168
    ds_write_b32 v12, v223 offset:28208
    s_waitcnt lgkmcnt(0)
    s_barrier
    v_lshrrev_b32 v11, 5, v0
    v_and_b32 v12, 31, v0
    s_movk_i32 s9, 1040
    v_mul_lo_u32 v13, v11, s9
    v_lshl_add_u32 v13, v12, 5, v13
    s_lshl_b32 s8, s4, 6
    v_add_u32 v11, s8, v11
    s_movk_i32 s9, 3584
    v_mul_lo_u32 v11, v11, s9
    v_lshl_add_u32 v11, v12, 4, v11
    s_lshl_b32 s9, s5, 9
    v_add_u32 v11, s9, v11
    s_mov_b32 s14, 8
K3_E:
    ds_read_b128 v[64:67], v13
    ds_read_b128 v[68:71], v13 offset:16
    v_add_u32 v13, 8320, v13
    s_waitcnt lgkmcnt(0)
    v_cvt_pk_bf16_f32 v64, v64, v64
    v_and_b32 v64, 0xffff0000, v64
    v_mul_f32 v72, 0xbfb8aa3b, v64
    v_exp_f32 v72, v72
    v_cvt_pk_bf16_f32 v65, v65, v65
    v_and_b32 v65, 0xffff0000, v65
    v_mul_f32 v73, 0xbfb8aa3b, v65
    v_exp_f32 v73, v73
    v_cvt_pk_bf16_f32 v66, v66, v66
    v_and_b32 v66, 0xffff0000, v66
    v_mul_f32 v74, 0xbfb8aa3b, v66
    v_exp_f32 v74, v74
    v_cvt_pk_bf16_f32 v67, v67, v67
    v_and_b32 v67, 0xffff0000, v67
    v_mul_f32 v75, 0xbfb8aa3b, v67
    v_exp_f32 v75, v75
    v_cvt_pk_bf16_f32 v68, v68, v68
    v_and_b32 v68, 0xffff0000, v68
    v_mul_f32 v76, 0xbfb8aa3b, v68
    v_exp_f32 v76, v76
    v_cvt_pk_bf16_f32 v69, v69, v69
    v_and_b32 v69, 0xffff0000, v69
    v_mul_f32 v77, 0xbfb8aa3b, v69
    v_exp_f32 v77, v77
    v_cvt_pk_bf16_f32 v70, v70, v70
    v_and_b32 v70, 0xffff0000, v70
    v_mul_f32 v78, 0xbfb8aa3b, v70
    v_exp_f32 v78, v78
    v_cvt_pk_bf16_f32 v71, v71, v71
    v_and_b32 v71, 0xffff0000, v71
    v_mul_f32 v79, 0xbfb8aa3b, v71
    v_exp_f32 v79, v79
    v_add_f32 v72, 1.0, v72
    v_add_f32 v73, 1.0, v73
    v_add_f32 v74, 1.0, v74
    v_add_f32 v75, 1.0, v75
    v_add_f32 v76, 1.0, v76
    v_add_f32 v77, 1.0, v77
    v_add_f32 v78, 1.0, v78
    v_add_f32 v79, 1.0, v79
    v_rcp_f32 v72, v72
    v_rcp_f32 v73, v73
    v_rcp_f32 v74, v74
    v_rcp_f32 v75, v75
    v_rcp_f32 v76, v76
    v_rcp_f32 v77, v77
    v_rcp_f32 v78, v78
    v_rcp_f32 v79, v79
    s_nop 0
    v_mul_f32 v64, v64, v72
    v_mul_f32 v65, v65, v73
    v_mul_f32 v66, v66, v74
    v_mul_f32 v67, v67, v75
    v_mul_f32 v68, v68, v76
    v_mul_f32 v69, v69, v77
    v_mul_f32 v70, v70, v78
    v_mul_f32 v71, v71, v79
    v_cvt_pk_bf16_f32 v80, v64, v65
    v_cvt_pk_bf16_f32 v81, v66, v67
    v_cvt_pk_bf16_f32 v82, v68, v69
    v_cvt_pk_bf16_f32 v83, v70, v71
    buffer_store_dwordx4 v[80:83], v11, s[44:47], 0 offen
    v_add_u32 v11, 28672, v11
    s_sub_u32 s14, s14, 1
    s_cmp_lg_u32 s14, 0
    s_cbranch_scc1 K3_E
    s_waitcnt vmcnt(0)
K3_END:
    s_endpgm
.globl k4_ffn2_kernel
.p2align 8
.type k4_ffn2_kernel,@function
k4_ffn2_kernel:
    s_cmp_ge_u32 s2, 256
    s_cbranch_scc1 K4_END
    s_load_dwordx2 s[8:9], s[0:1], 96
    s_load_dwordx2 s[32:33], s[0:1], 112
    v_lshrrev_b32 v1, 6, v0
    s_nop 1
    v_readfirstlane_b32 s3, v1
    v_and_b32 v1, 63, v0
    s_and_b32 s4, s2, 7
    s_lshl_b32 s4, s4, 2
    s_lshr_b32 s5, s2, 3
    s_and_b32 s5, s5, 3
    s_add_u32 s4, s4, s5
    s_lshl_b32 s4, s4, 6
    s_lshr_b32 s5, s2, 5
    s_lshl_b32 s5, s5, 6
    s_waitcnt lgkmcnt(0)
    s_add_u32 s36, s32, 11010048
    s_addc_u32 s37, s33, 0
    s_and_b32 s37, s37, 0xffff
    s_mov_b32 s38, 2162688
    s_mov_b32 s39, 0x00020000
    s_add_u32 s40, s32, 8912896
    s_addc_u32 s41, s33, 0
    s_and_b32 s41, s41, 0xffff
    s_mov_b32 s42, 1835008
    s_mov_b32 s43, 0x00020000
    s_add_u32 s44, s32, 13369344
    s_addc_u32 s45, s33, 0
    s_and_b32 s45, s45, 0xffff
    s_mov_b32 s46, 7340032
    s_mov_b32 s47, 0x00020000
    s_mov_b32 s48, s8
    s_and_b32 s49, s9, 0xffff
    s_mov_b32 s50, 2097152
    s_mov_b32 s51, 0x00020000
    v_and_b32 v2, 31, v1
    v_lshrrev_b32 v3, 5, v1
    v_lshrrev_b32 v4, 4, v1
    v_and_b32 v5, 15, v1
    s_movk_i32 s9, 3584
    s_lshl_b32 s6, s3, 4
    v_add_u32 v6, 0, v4
    v_xor_b32 v7, v6, v5
    v_add_u32 v6, s6, v6
    v_add_u32 v8, s4, v6
    v_mul_lo_u32 v8, v8, s9
    v_lshl_add_u32 v20, v7, 4, v8
    v_add_u32 v8, s5, v6
    v_mul_lo_u32 v8, v8, s9
    v_lshl_add_u32 v24, v7, 4, v8
    v_add_u32 v6, 4, v4
    v_xor_b32 v7, v6, v5
    v_add_u32 v6, s6, v6
    v_add_u32 v8, s4, v6
    v_mul_lo_u32 v8, v8, s9
    v_lshl_add_u32 v21, v7, 4, v8
    v_add_u32 v8, s5, v6
    v_mul_lo_u32 v8, v8, s9
    v_lshl_add_u32 v25, v7, 4, v8
    v_add_u32 v6, 8, v4
    v_xor_b32 v7, v6, v5
    v_add_u32 v6, s6, v6
    v_add_u32 v8, s4, v6
    v_mul_lo_u32 v8, v8, s9
    v_lshl_add_u32 v22, v7, 4, v8
    v_add_u32 v8, s5, v6
    v_mul_lo_u32 v8, v8, s9
    v_lshl_add_u32 v26, v7, 4, v8
    v_add_u32 v6, 12, v4
    v_xor_b32 v7, v6, v5
    v_add_u32 v6, s6, v6
    v_add_u32 v8, s4, v6
    v_mul_lo_u32 v8, v8, s9
    v_lshl_add_u32 v23, v7, 4, v8
    v_add_u32 v8, s5, v6
    v_mul_lo_u32 v8, v8, s9
    v_lshl_add_u32 v27, v7, 4, v8
    s_lshl_b32 s7, s3, 12
    s_mov_b32 s13, 0
    s_mov_b32 s16, 0
    s_add_u32 s12, s16, s7
    s_add_u32 m0, s12, 0
    s_nop 0
    buffer_load_dwordx4 v20, s[44:47], s13 offen lds
    s_add_u32 m0, s12, 16384
    s_nop 0
    buffer_load_dwordx4 v24, s[40:43], s13 offen lds
    s_add_u32 s12, s16, s7
    s_add_u32 m0, s12, 1024
    s_nop 0
    buffer_load_dwordx4 v21, s[44:47], s13 offen lds
    s_add_u32 m0, s12, 17408
    s_nop 0
    buffer_load_dwordx4 v25, s[40:43], s13 offen lds
    s_add_u32 s12, s16, s7
    s_add_u32 m0, s12, 2048
    s_nop 0
    buffer_load_dwordx4 v22, s[44:47], s13 offen lds
    s_add_u32 m0, s12, 18432
    s_nop 0
    buffer_load_dwordx4 v26, s[40:43], s13 offen lds
    s_add_u32 s12, s16, s7
    s_add_u32 m0, s12, 3072
    s_nop 0
    buffer_load_dwordx4 v23, s[44:47], s13 offen lds
    s_add_u32 m0, s12, 19456
    s_nop 0
    buffer_load_dwordx4 v27, s[40:43], s13 offen lds
    s_add_u32 s13, s13, 256
    s_add_u32 s16, s16, 32768
    s_cmp_eq_u32 s16, 98304
    s_cselect_b32 s16, 0, s16
    s_add_u32 s12, s16, s7
    s_add_u32 m0, s12, 0
    s_nop 0
    buffer_load_dwordx4 v20, s[44:47], s13 offen lds
    s_add_u32 m0, s12, 16384
    s_nop 0
    buffer_load_dwordx4 v24, s[40:43], s13 offen lds
    s_add_u32 s12, s16, s7
    s_add_u32 m0, s12, 1024
    s_nop 0
    buffer_load_dwordx4 v21, s[44:47], s13 offen lds
    s_add_u32 m0, s12, 17408
    s_nop 0
    buffer_load_dwordx4 v25, s[40:43], s13 offen lds
    s_add_u32 s12, s16, s7
    s_add_u32 m0, s12, 2048
    s_nop 0
    buffer_load_dwordx4 v22, s[44:47], s13 offen lds
    s_add_u32 m0, s12, 18432
    s_nop 0
    buffer_load_dwordx4 v26, s[40:43], s13 offen lds
    s_add_u32 s12, s16, s7
    s_add_u32 m0, s12, 3072
    s_nop 0
    buffer_load_dwordx4 v23, s[44:47], s13 offen lds
    s_add_u32 m0, s12, 19456
    s_nop 0
    buffer_load_dwordx4 v27, s[40:43], s13 offen lds
    s_add_u32 s13, s13, 256
    s_add_u32 s16, s16, 32768
    s_cmp_eq_u32 s16, 98304
    s_cselect_b32 s16, 0, s16
    s_lshl_b32 s6, s3, 2
    v_add_u32 v6, 0, v3
    v_add_u32 v6, s6, v6
    v_xor_b32 v6, v6, v5
    v_lshlrev_b32 v6, 4, v6
    v_lshl_add_u32 v28, v2, 8, v6
    v_add_u32 v6, 2, v3
    v_add_u32 v6, s6, v6
    v_xor_b32 v6, v6, v5
    v_lshlrev_b32 v6, 4, v6
    v_lshl_add_u32 v29, v2, 8, v6
    v_lshrrev_b32 v9, 2, v0
    v_and_b32 v10, 3, v0
    v_lshlrev_b32 v10, 4, v10
    v_mov_b32 v160, 0
    v_mov_b32 v161, 0
    v_mov_b32 v162, 0
    v_mov_b32 v163, 0
    v_mov_b32 v164, 0
    v_mov_b32 v165, 0
    v_mov_b32 v166, 0
    v_mov_b32 v167, 0
    v_mov_b32 v168, 0
    v_mov_b32 v169, 0
    v_mov_b32 v170, 0
    v_mov_b32 v171, 0
    v_mov_b32 v172, 0
    v_mov_b32 v173, 0
    v_mov_b32 v174, 0
    v_mov_b32 v175, 0
    v_mov_b32 v176, 0
    v_mov_b32 v177, 0
    v_mov_b32 v178, 0
    v_mov_b32 v179, 0
    v_mov_b32 v180, 0
    v_mov_b32 v181, 0
    v_mov_b32 v182, 0
    v_mov_b32 v183, 0
    v_mov_b32 v184, 0
    v_mov_b32 v185, 0
    v_mov_b32 v186, 0
    v_mov_b32 v187, 0
    v_mov_b32 v188, 0
    v_mov_b32 v189, 0
    v_mov_b32 v190, 0
    v_mov_b32 v191, 0
    v_mov_b32 v192, 0
    v_mov_b32 v193, 0
    v_mov_b32 v194, 0
    v_mov_b32 v195, 0
    v_mov_b32 v196, 0
    v_mov_b32 v197, 0
    v_mov_b32 v198, 0
    v_mov_b32 v199, 0
    v_mov_b32 v200, 0
    v_mov_b32 v201, 0
    v_mov_b32 v202, 0
    v_mov_b32 v203, 0
    v_mov_b32 v204, 0
    v_mov_b32 v205, 0
    v_mov_b32 v206, 0
    v_mov_b32 v207, 0
    v_mov_b32 v208, 0
    v_mov_b32 v209, 0
    v_mov_b32 v210, 0
    v_mov_b32 v211, 0
    v_mov_b32 v212, 0
    v_mov_b32 v213, 0
    v_mov_b32 v214, 0
    v_mov_b32 v215, 0
    v_mov_b32 v216, 0
    v_mov_b32 v217, 0
    v_mov_b32 v218, 0
    v_mov_b32 v219, 0
    v_mov_b32 v220, 0
    v_mov_b32 v221, 0
    v_mov_b32 v222, 0
    v_mov_b32 v223, 0
    s_mov_b32 s17, 0
    s_mov_b32 s14, 14
K4_L:
    s_waitcnt vmcnt(8)
    s_barrier
    v_add_u32 v30, s17, v28
    v_add_u32 v31, s17, v29
    ds_read_b128 v[64:67], v30 offset:0
    ds_read_b128 v[72:75], v30 offset:16384
    ds_read_b128 v[68:71], v30 offset:8192
    ds_read_b128 v[76:79], v30 offset:24576
    ds_read_b128 v[80:83], v31 offset:0
    ds_read_b128 v[88:91], v31 offset:16384
    ds_read_b128 v[84:87], v31 offset:8192
    ds_read_b128 v[92:95], v31 offset:24576
    s_add_u32 s12, s16, s7
    s_add_u32 m0, s12, 0
    s_nop 0
    buffer_load_dwordx4 v20, s[44:47], s13 offen lds
    s_add_u32 m0, s12, 16384
    s_nop 0
    buffer_load_dwordx4 v24, s[40:43], s13 offen lds
    s_add_u32 s12, s16, s7
    s_add_u32 m0, s12, 1024
    s_nop 0
    buffer_load_dwordx4 v21, s[44:47], s13 offen lds
    s_add_u32 m0, s12, 17408
    s_nop 0
    buffer_load_dwordx4 v25, s[40:43], s13 offen lds
    s_add_u32 s12, s16, s7
    s_add_u32 m0, s12, 2048
    s_nop 0
    buffer_load_dwordx4 v22, s[44:47], s13 offen lds
    s_add_u32 m0, s12, 18432
    s_nop 0
    buffer_load_dwordx4 v26, s[40:43], s13 offen lds
    s_add_u32 s12, s16, s7
    s_add_u32 m0, s12, 3072
    s_nop 0
    buffer_load_dwordx4 v23, s[44:47], s13 offen lds
    s_add_u32 m0, s12, 19456
    s_nop 0
    buffer_load_dwordx4 v27, s[40:43], s13 offen lds
    s_add_u32 s13, s13, 256
    s_add_u32 s16, s16, 32768
    s_cmp_eq_u32 s16, 98304
    s_cselect_b32 s16, 0, s16
    s_add_u32 s17, s17, 32768
    s_cmp_eq_u32 s17, 98304
    s_cselect_b32 s17, 0, s17
    s_waitcnt lgkmcnt(4)
    v_mfma_f32_32x32x16_bf16 v[160:175], v[64:67], v[72:75], v[160:175]
    v_mfma_f32_32x32x16_bf16 v[176:191], v[64:67], v[76:79], v[176:191]
    v_mfma_f32_32x32x16_bf16 v[192:207], v[68:71], v[72:75], v[192:207]
    v_mfma_f32_32x32x16_bf16 v[208:223], v[68:71], v[76:79], v[208:223]
    s_waitcnt lgkmcnt(0)
    v_mfma_f32_32x32x16_bf16 v[160:175], v[80:83], v[88:91], v[160:175]
    v_mfma_f32_32x32x16_bf16 v[176:191], v[80:83], v[92:95], v[176:191]
    v_mfma_f32_32x32x16_bf16 v[192:207], v[84:87], v[88:91], v[192:207]
    v_mfma_f32_32x32x16_bf16 v[208:223], v[84:87], v[92:95], v[208:223]
    s_sub_u32 s14, s14, 1
    s_cmp_lg_u32 s14, 0
    s_cbranch_scc1 K4_L
    v_add_u32 v11, s5, v10
    s_mov_b32 s10, 4224
    v_mul_lo_u32 v11, v11, s10
    v_add_u32 v12, s4, v9
    v_lshl_add_u32 v11, v12, 1, v11
    buffer_load_ushort v32, v11, s[36:39], 0 offen
    v_add_u32 v11, 4224, v11
    buffer_load_ushort v33, v11, s[36:39], 0 offen
    v_add_u32 v11, 4224, v11
    buffer_load_ushort v34, v11, s[36:39], 0 offen
    v_add_u32 v11, 4224, v11
    buffer_load_ushort v35, v11, s[36:39], 0 offen
    v_add_u32 v11, 4224, v11
    buffer_load_ushort v36, v11, s[36:39], 0 offen
    v_add_u32 v11, 4224, v11
    buffer_load_ushort v37, v11, s[36:39], 0 offen
    v_add_u32 v11, 4224, v11
    buffer_load_ushort v38, v11, s[36:39], 0 offen
    v_add_u32 v11, 4224, v11
    buffer_load_ushort v39, v11, s[36:39], 0 offen
    v_add_u32 v11, 4224, v11
    buffer_load_ushort v40, v11, s[36:39], 0 offen
    v_add_u32 v11, 4224, v11
    buffer_load_ushort v41, v11, s[36:39], 0 offen
    v_add_u32 v11, 4224, v11
    buffer_load_ushort v42, v11, s[36:39], 0 offen
    v_add_u32 v11, 4224, v11
    buffer_load_ushort v43, v11, s[36:39], 0 offen
    v_add_u32 v11, 4224, v11
    buffer_load_ushort v44, v11, s[36:39], 0 offen
    v_add_u32 v11, 4224, v11
    buffer_load_ushort v45, v11, s[36:39], 0 offen
    v_add_u32 v11, 4224, v11
    buffer_load_ushort v46, v11, s[36:39], 0 offen
    v_add_u32 v11, 4224, v11
    buffer_load_ushort v47, v11, s[36:39], 0 offen
    v_add_u32 v11, 4224, v11
    s_waitcnt vmcnt(16)
    s_barrier
    s_lshl_b32 s6, s3, 14
    v_lshlrev_b32 v8, 10, v3
    v_lshl_add_u32 v8, v2, 2, v8
    v_add_u32 v8, s6, v8
    ds_write_b32 v8, v160 offset:0
    ds_write_b32 v8, v161 offset:256
    ds_write_b32 v8, v162 offset:512
    ds_write_b32 v8, v163 offset:768
    ds_write_b32 v8, v164 offset:2048
    ds_write_b32 v8, v165 offset:2304
    ds_write_b32 v8, v166 offset:2560
    ds_write_b32 v8, v167 offset:2816
    ds_write_b32 v8, v168 offset:4096
    ds_write_b32 v8, v169 offset:4352
    ds_write_b32 v8, v170 offset:4608
    ds_write_b32 v8, v171 offset:4864
    ds_write_b32 v8, v172 offset:6144
    ds_write_b32 v8, v173 offset:6400
    ds_write_b32 v8, v174 offset:6656
    ds_write_b32 v8, v175 offset:6912
    ds_write_b32 v8, v176 offset:128
    ds_write_b32 v8, v177 offset:384
    ds_write_b32 v8, v178 offset:640
    ds_write_b32 v8, v179 offset:896
    ds_write_b32 v8, v180 offset:2176
    ds_write_b32 v8, v181 offset:2432
    ds_write_b32 v8, v182 offset:2688
    ds_write_b32 v8, v183 offset:2944
    ds_write_b32 v8, v184 offset:4224
    ds_write_b32 v8, v185 offset:4480
    ds_write_b32 v8, v186 offset:4736
    ds_write_b32 v8, v187 offset:4992
    ds_write_b32 v8, v188 offset:6272
    ds_write_b32 v8, v189 offset:6528
    ds_write_b32 v8, v190 offset:6784
    ds_write_b32 v8, v191 offset:7040
    ds_write_b32 v8, v192 offset:8192
    ds_write_b32 v8, v193 offset:8448
    ds_write_b32 v8, v194 offset:8704
    ds_write_b32 v8, v195 offset:8960
    ds_write_b32 v8, v196 offset:10240
    ds_write_b32 v8, v197 offset:10496
    ds_write_b32 v8, v198 offset:10752
    ds_write_b32 v8, v199 offset:11008
    ds_write_b32 v8, v200 offset:12288
    ds_write_b32 v8, v201 offset:12544
    ds_write_b32 v8, v202 offset:12800
    ds_write_b32 v8, v203 offset:13056
    ds_write_b32 v8, v204 offset:14336
    ds_write_b32 v8, v205 offset:14592
    ds_write_b32 v8, v206 offset:14848
    ds_write_b32 v8, v207 offset:15104
    ds_write_b32 v8, v208 offset:8320
    ds_write_b32 v8, v209 offset:8576
    ds_write_b32 v8, v210 offset:8832
    ds_write_b32 v8, v211 offset:9088
    ds_write_b32 v8, v212 offset:10368
    ds_write_b32 v8, v213 offset:10624
    ds_write_b32 v8, v214 offset:10880
    ds_write_b32 v8, v215 offset:11136
    ds_write_b32 v8, v216 offset:12416
    ds_write_b32 v8, v217 offset:12672
    ds_write_b32 v8, v218 offset:12928
    ds_write_b32 v8, v219 offset:13184
    ds_write_b32 v8, v220 offset:14464
    ds_write_b32 v8, v221 offset:14720
    ds_write_b32 v8, v222 offset:14976
    ds_write_b32 v8, v223 offset:15232
    s_waitcnt lgkmcnt(0)
    s_barrier
    v_lshlrev_b32 v13, 8, v9
    v_lshl_add_u32 v13, v10, 2, v13
    ds_read_b128 v[64:67], v13 offset:0
    ds_read_b128 v[68:71], v13 offset:16
    ds_read_b128 v[72:75], v13 offset:32
    ds_read_b128 v[76:79], v13 offset:48
    ds_read_b128 v[80:83], v13 offset:16384
    ds_read_b128 v[84:87], v13 offset:16400
    ds_read_b128 v[88:91], v13 offset:16416
    ds_read_b128 v[92:95], v13 offset:16432
    ds_read_b128 v[96:99], v13 offset:32768
    ds_read_b128 v[100:103], v13 offset:32784
    ds_read_b128 v[104:107], v13 offset:32800
    ds_read_b128 v[108:111], v13 offset:32816
    ds_read_b128 v[112:115], v13 offset:49152
    ds_read_b128 v[116:119], v13 offset:49168
    ds_read_b128 v[120:123], v13 offset:49184
    ds_read_b128 v[124:127], v13 offset:49200
    s_waitcnt vmcnt(0) lgkmcnt(0)
    v_add_f32 v64, v64, v80
    v_add_f32 v96, v96, v112
    v_add_f32 v64, v64, v96
    v_cvt_pk_bf16_f32 v64, v64, v64
    v_and_b32 v64, 0xffff0000, v64
    v_lshlrev_b32 v32, 16, v32
    v_add_f32 v64, v64, v32

    v_add_f32 v65, v65, v81
    v_add_f32 v97, v97, v113
    v_add_f32 v65, v65, v97
    v_cvt_pk_bf16_f32 v65, v65, v65
    v_and_b32 v65, 0xffff0000, v65
    v_lshlrev_b32 v33, 16, v33
    v_add_f32 v65, v65, v33

    v_add_f32 v66, v66, v82
    v_add_f32 v98, v98, v114
    v_add_f32 v66, v66, v98
    v_cvt_pk_bf16_f32 v66, v66, v66
    v_and_b32 v66, 0xffff0000, v66
    v_lshlrev_b32 v34, 16, v34
    v_add_f32 v66, v66, v34

    v_add_f32 v67, v67, v83
    v_add_f32 v99, v99, v115
    v_add_f32 v67, v67, v99
    v_cvt_pk_bf16_f32 v67, v67, v67
    v_and_b32 v67, 0xffff0000, v67
    v_lshlrev_b32 v35, 16, v35
    v_add_f32 v67, v67, v35

    v_add_f32 v68, v68, v84
    v_add_f32 v100, v100, v116
    v_add_f32 v68, v68, v100
    v_cvt_pk_bf16_f32 v68, v68, v68
    v_and_b32 v68, 0xffff0000, v68
    v_lshlrev_b32 v36, 16, v36
    v_add_f32 v68, v68, v36

    v_add_f32 v69, v69, v85
    v_add_f32 v101, v101, v117
    v_add_f32 v69, v69, v101
    v_cvt_pk_bf16_f32 v69, v69, v69
    v_and_b32 v69, 0xffff0000, v69
    v_lshlrev_b32 v37, 16, v37
    v_add_f32 v69, v69, v37

    v_add_f32 v70, v70, v86
    v_add_f32 v102, v102, v118
    v_add_f32 v70, v70, v102
    v_cvt_pk_bf16_f32 v70, v70, v70
    v_and_b32 v70, 0xffff0000, v70
    v_lshlrev_b32 v38, 16, v38
    v_add_f32 v70, v70, v38

    v_add_f32 v71, v71, v87
    v_add_f32 v103, v103, v119
    v_add_f32 v71, v71, v103
    v_cvt_pk_bf16_f32 v71, v71, v71
    v_and_b32 v71, 0xffff0000, v71
    v_lshlrev_b32 v39, 16, v39
    v_add_f32 v71, v71, v39

    v_add_f32 v72, v72, v88
    v_add_f32 v104, v104, v120
    v_add_f32 v72, v72, v104
    v_cvt_pk_bf16_f32 v72, v72, v72
    v_and_b32 v72, 0xffff0000, v72
    v_lshlrev_b32 v40, 16, v40
    v_add_f32 v72, v72, v40

    v_add_f32 v73, v73, v89
    v_add_f32 v105, v105, v121
    v_add_f32 v73, v73, v105
    v_cvt_pk_bf16_f32 v73, v73, v73
    v_and_b32 v73, 0xffff0000, v73
    v_lshlrev_b32 v41, 16, v41
    v_add_f32 v73, v73, v41

    v_add_f32 v74, v74, v90
    v_add_f32 v106, v106, v122
    v_add_f32 v74, v74, v106
    v_cvt_pk_bf16_f32 v74, v74, v74
    v_and_b32 v74, 0xffff0000, v74
    v_lshlrev_b32 v42, 16, v42
    v_add_f32 v74, v74, v42

    v_add_f32 v75, v75, v91
    v_add_f32 v107, v107, v123
    v_add_f32 v75, v75, v107
    v_cvt_pk_bf16_f32 v75, v75, v75
    v_and_b32 v75, 0xffff0000, v75
    v_lshlrev_b32 v43, 16, v43
    v_add_f32 v75, v75, v43

    v_add_f32 v76, v76, v92
    v_add_f32 v108, v108, v124
    v_add_f32 v76, v76, v108
    v_cvt_pk_bf16_f32 v76, v76, v76
    v_and_b32 v76, 0xffff0000, v76
    v_lshlrev_b32 v44, 16, v44
    v_add_f32 v76, v76, v44

    v_add_f32 v77, v77, v93
    v_add_f32 v109, v109, v125
    v_add_f32 v77, v77, v109
    v_cvt_pk_bf16_f32 v77, v77, v77
    v_and_b32 v77, 0xffff0000, v77
    v_lshlrev_b32 v45, 16, v45
    v_add_f32 v77, v77, v45

    v_add_f32 v78, v78, v94
    v_add_f32 v110, v110, v126
    v_add_f32 v78, v78, v110
    v_cvt_pk_bf16_f32 v78, v78, v78
    v_and_b32 v78, 0xffff0000, v78
    v_lshlrev_b32 v46, 16, v46
    v_add_f32 v78, v78, v46

    v_add_f32 v79, v79, v95
    v_add_f32 v111, v111, v127
    v_add_f32 v79, v79, v111
    v_cvt_pk_bf16_f32 v79, v79, v79
    v_and_b32 v79, 0xffff0000, v79
    v_lshlrev_b32 v47, 16, v47
    v_add_f32 v79, v79, v47

    v_cvt_pk_bf16_f32 v48, v64, v65
    v_cvt_pk_bf16_f32 v49, v66, v67
    v_cvt_pk_bf16_f32 v50, v68, v69
    v_cvt_pk_bf16_f32 v51, v70, v71
    v_cvt_pk_bf16_f32 v52, v72, v73
    v_cvt_pk_bf16_f32 v53, v74, v75
    v_cvt_pk_bf16_f32 v54, v76, v77
    v_cvt_pk_bf16_f32 v55, v78, v79
    v_lshlrev_b32 v14, 10, v12
    v_add_u32 v15, s5, v10
    v_lshl_add_u32 v14, v15, 1, v14
    buffer_store_dwordx4 v[48:51], v14, s[48:51], 0 offen
    buffer_store_dwordx4 v[52:55], v14, s[48:51], 0 offen offset:16
    s_waitcnt vmcnt(0)
K4_END:
    s_endpgm
.section .rodata,"a"
.p2align 6
.amdhsa_kernel k1_prep_kernel
  .amdhsa_next_free_vgpr 128
  .amdhsa_next_free_sgpr 102
  .amdhsa_accum_offset 128
  .amdhsa_group_segment_fixed_size 0
  .amdhsa_kernarg_size 120
  .amdhsa_user_sgpr_count 2
  .amdhsa_user_sgpr_kernarg_segment_ptr 1
  .amdhsa_system_sgpr_workgroup_id_x 1
.end_amdhsa_kernel
.p2align 6
.amdhsa_kernel k2_conv_kernel
  .amdhsa_next_free_vgpr 64
  .amdhsa_next_free_sgpr 102
  .amdhsa_accum_offset 64
  .amdhsa_group_segment_fixed_size 0
  .amdhsa_kernarg_size 120
  .amdhsa_user_sgpr_count 2
  .amdhsa_user_sgpr_kernarg_segment_ptr 1
  .amdhsa_system_sgpr_workgroup_id_x 1
.end_amdhsa_kernel
.p2align 6
.amdhsa_kernel k3_ffn1_kernel
  .amdhsa_next_free_vgpr 224
  .amdhsa_next_free_sgpr 102
  .amdhsa_accum_offset 224
  .amdhsa_group_segment_fixed_size 0
  .amdhsa_kernarg_size 120
  .amdhsa_user_sgpr_count 2
  .amdhsa_user_sgpr_kernarg_segment_ptr 1
  .amdhsa_system_sgpr_workgroup_id_x 1
.end_amdhsa_kernel
.p2align 6
.amdhsa_kernel k4_ffn2_kernel
  .amdhsa_next_free_vgpr 224
  .amdhsa_next_free_sgpr 102
  .amdhsa_accum_offset 224
  .amdhsa_group_segment_fixed_size 0
  .amdhsa_kernarg_size 120
  .amdhsa_user_sgpr_count 2
  .amdhsa_user_sgpr_kernarg_segment_ptr 1
  .amdhsa_system_sgpr_workgroup_id_x 1
.end_amdhsa_kernel
```
